```python
import torch

def _softmax(x, axis=-1):
    return torch.softmax(x, dim=axis)
def _gelu(x):
    return torch.nn.functional.gelu(x, approximate="tanh")
def _silu(x):
    return torch.nn.functional.silu(x)
def _sigmoid(x):
    return torch.sigmoid(x)
def _layernorm(x, axis=-1, eps=1e-5):
    m = x.mean(dim=axis, keepdim=True)
    v = x.var(dim=axis, keepdim=True, unbiased=False)
    return (x - m) / torch.sqrt(v + eps)
def _scatter_add(tgt, idx, src, axis=0):
    return tgt.clone().index_add_(axis, idx, src)
def _segment_sum(src, seg, n):
    out = torch.zeros((n,) + src.shape[1:], dtype=src.dtype)
    return out.index_add_(0, seg, src)
def _pad(x, pw):
    flat = tuple(v for pair in reversed(pw) for v in pair)
    return torch.nn.functional.pad(x, flat)

kernel_name = 'concat_heads__sliding_block__sliding_block__prompt'

def setup_inputs():

    _w = (lambda a: (lambda t: t.to(torch.bfloat16) if t.is_floating_point() else t)(torch.as_tensor(a)))
    def _A_setup():
        B, S, D = 1, 2048, 576
        return {
            "x": _w((lambda *s: torch.randn(*s, dtype=torch.bfloat16) * 0.2)(B, S, D)),
            "wqkv": _w((lambda *s: torch.randn(*s, dtype=torch.bfloat16) * 0.2)(D, 3 * D)),
            "wo": _w((lambda *s: torch.randn(*s, dtype=torch.bfloat16) * 0.05)(D, D)),
        }
    _A_in = _A_setup()

    def _B_setup():
        B, S, D = 1, 2048, 576
        return {
            "x": _w((lambda *s: torch.randn(*s, dtype=torch.bfloat16) * 0.2)(B, S, D)),
            "wqkv": _w((lambda *s: torch.randn(*s, dtype=torch.bfloat16) * 0.2)(D, 3 * D)),
            "wo": _w((lambda *s: torch.randn(*s, dtype=torch.bfloat16) * 0.05)(D, D)),
        }
    _B_in = _B_setup()

    return {
        "A_x": _A_in["x"],
        "A_wqkv": _A_in["wqkv"],
        "A_wo": _A_in["wo"],
        "B_x": _B_in["x"],
        "B_wqkv": _B_in["wqkv"],
        "B_wo": _B_in["wo"],
    }

def reference(A_x, A_wqkv, A_wo, B_x, B_wqkv, B_wo):
    def _A_ref(x, wqkv, wo):
        B, S, D = x.shape
        H = 32; Dh = D // H; W = 256
        qkv = (lambda x, *d: x.permute(*d))((x @ wqkv).reshape(B, S, 3, H, Dh), 2, 0, 3, 1, 4)
        q, k, v = qkv[0], qkv[1], qkv[2]
        scores = torch.einsum("bhqd,bhkd->bhqk", q, k) * (Dh ** -0.5)
        idx = torch.arange(S)
        mask = (idx[:, None] - idx[None, :] >= 0) & (idx[:, None] - idx[None, :] < W)
        scores = torch.where(mask[None, None], scores, -1e9)
        p = _softmax(scores, axis=-1)
        o = torch.einsum("bhqk,bhkd->bhqd", p, v)
        return (lambda x, *d: x.permute(*d))(o, 0, 2, 1, 3).reshape(B, S, D) @ wo

    def _B_ref(x, wqkv, wo):
        B, S, D = x.shape
        H = 32; Dh = D // H; W = 256
        qkv = (lambda x, *d: x.permute(*d))((x @ wqkv).reshape(B, S, 3, H, Dh), 2, 0, 3, 1, 4)
        q, k, v = qkv[0], qkv[1], qkv[2]
        scores = torch.einsum("bhqd,bhkd->bhqk", q, k) * (Dh ** -0.5)
        idx = torch.arange(S)
        mask = (idx[:, None] - idx[None, :] >= 0) & (idx[:, None] - idx[None, :] < W)
        scores = torch.where(mask[None, None], scores, -1e9)
        p = _softmax(scores, axis=-1)
        o = torch.einsum("bhqk,bhkd->bhqd", p, v)
        return (lambda x, *d: x.permute(*d))(o, 0, 2, 1, 3).reshape(B, S, D) @ wo

    a = _A_ref(A_x, A_wqkv, A_wo)
    b = _B_ref(B_x, B_wqkv, B_wo)
    return torch.concatenate([a, b], axis=-1)
```

```asm
; @launch grid=(256,1,1) block=(512,1,1) lds=163840
  .amdgcn_target "amdgcn-amd-amdhsa--gfx950"
  .text
  .globl concat_heads__sliding_block__sliding_block__prompt_kernel
  .p2align 8
  .type concat_heads__sliding_block__sliding_block__prompt_kernel,@function
concat_heads__sliding_block__sliding_block__prompt_kernel:
  s_cmp_ge_u32 s2, 256
  s_cbranch_scc1 L_END
  s_and_b32 s3, s2, 7
  s_lshr_b32 s28, s3, 2
  s_mul_i32 s32, s28, 24
  s_add_u32 s4, s0, s32
  s_addc_u32 s5, s1, 0
  s_load_dwordx2 s[8:9], s[4:5], 0
  s_load_dwordx2 s[12:13], s[4:5], 8
  s_load_dwordx2 s[16:17], s[4:5], 16
  s_load_dwordx2 s[24:25], s[0:1], 48
  s_load_dwordx2 s[20:21], s[0:1], 64
  s_lshr_b32 s38, s2, 3
  s_lshr_b32 s34, s3, 1
  s_and_b32 s34, s34, 1
  s_lshl_b32 s34, s34, 2
  s_and_b32 s35, s38, 3
  s_add_u32 s29, s34, s35
  s_and_b32 s34, s3, 1
  s_lshl_b32 s34, s34, 3
  s_lshr_b32 s36, s38, 2
  s_add_u32 s30, s34, s36
  s_lshl_b32 s35, s35, 1
  s_add_u32 s44, s36, s35
  s_cmp_ge_u32 s44, 9
  s_cselect_b32 s35, 9, 0
  s_sub_u32 s44, s44, s35
  s_lshr_b32 s44, s36, 1
  s_and_b32 s35, s38, 3
  s_add_u32 s44, s44, s35
  s_mul_i32 s44, s44, 2
  s_cmp_ge_u32 s44, 9
  s_cselect_b32 s35, 9, 0
  s_sub_u32 s44, s44, s35
  s_cmp_ge_u32 s44, 9
  s_cselect_b32 s35, 9, 0
  s_sub_u32 s44, s44, s35
  s_lshl_b32 s32, s28, 4
  s_add_u32 s32, s32, s30
  s_lshl_b32 s32, s32, 3
  s_add_u32 s54, s32, s29
  s_lshl_b32 s32, s28, 3
  s_add_u32 s55, s32, s29
  v_lshrrev_b32 v2, 6, v0
  v_and_b32 v1, 63, v0
  v_readfirstlane_b32 s31, v2
  s_mov_b32 s10, 2359296
  s_mov_b32 s11, 0x00020000
  s_mov_b32 s14, 1990656
  s_mov_b32 s15, 0x00020000
  s_mov_b32 s18, 663552
  s_mov_b32 s19, 0x00020000
  s_mov_b32 s22, 268435456
  s_mov_b32 s23, 0x00020000
  s_mov_b32 s26, 4718592
  s_mov_b32 s27, 0x00020000
  s_and_b32 s57, s31, 3
  s_lshr_b32 s56, s31, 2
  s_sub_u32 s66, 7, s57
  s_lshl_b32 s32, s55, 18
  s_add_u32 s32, s32, 9437184
  s_lshl_b32 s33, s30, 10
  s_lshl_b32 s34, s56, 9
  s_add_u32 s33, s33, s34
  s_add_u32 s6, s33, s32
  s_lshl_b32 s32, s55, 15
  s_add_u32 s32, s32, 13631488
  s_lshl_b32 s33, s30, 1
  s_add_u32 s33, s33, s56
  s_lshl_b32 s33, s33, 10
  s_add_u32 s7, s33, s32
  s_lshl_b32 s5, s55, 12
  s_add_u32 s5, s5, 14221312
  s_cmp_lt_u32 s31, 4
  s_cbranch_scc1 L_COMPUTE
  s_sub_u32 s39, s31, 4
  v_lshrrev_b32 v2, 3, v1
  v_mul_u32_u24 v2, 1152, v2
  v_lshrrev_b32 v3, 4, v1
  v_and_b32 v4, 7, v1
  v_xor_b32 v5, v4, v3
  v_lshl_add_u32 v10, v5, 4, v2
  v_xor_b32 v5, 4, v5
  v_lshl_add_u32 v11, v5, 4, v2
  s_mul_i32 s32, s30, 72
  s_and_b32 s32, s32, 0xfffffff0
  v_and_b32 v4, 15, v1
  v_mul_u32_u24 v6, 3456, v3
  v_add_u32 v6, s32, v6
  v_lshlrev_b32 v5, 1, v3
  v_sub_u32 v5, v4, v5
  v_and_b32 v5, 15, v5
  v_min_u32 v5, 14, v5
  v_mul_u32_u24 v7, 13, v5
  v_lshrrev_b32 v7, 6, v7
  v_mul_u32_u24 v8, 5, v7
  v_sub_u32 v8, v5, v8
  v_mul_u32_u24 v7, 1152, v7
  v_lshl_add_u32 v8, v8, 4, v7
  v_add_u32 v12, v6, v8
  v_lshlrev_b32 v5, 1, v3
  v_sub_u32 v5, v4, v5
  v_subrev_u32 v5, 8, v5
  v_and_b32 v5, 15, v5
  v_min_u32 v5, 14, v5
  v_mul_u32_u24 v7, 13, v5
  v_lshrrev_b32 v7, 6, v7
  v_mul_u32_u24 v8, 5, v7
  v_sub_u32 v8, v5, v8
  v_mul_u32_u24 v7, 1152, v7
  v_lshl_add_u32 v8, v8, 4, v7
  v_add_u32 v13, v6, v8
  v_add_u32 v36, 0, v10
  v_add_u32 v37, 8192, v11
  v_add_u32 v38, 16384, v10
  v_add_u32 v39, 24576, v11
  v_add_u32 v40, 36864, v10
  v_add_u32 v41, 45056, v11
  v_add_u32 v42, 53248, v10
  v_add_u32 v43, 61440, v11
  v_add_u32 v44, 0, v12
  v_add_u32 v45, 12800, v12
  v_add_u32 v46, 25600, v13
  v_add_u32 v47, 38400, v13
  s_lshl_b32 s32, s29, 8
  s_lshl_b32 s33, s39, 6
  s_add_u32 s32, s32, s33
  s_mul_i32 s46, s32, 1152
  s_mul_i32 s47, s39, 55296
  s_lshl_b32 s48, s39, 13
  s_lshl_b32 s49, s39, 12
  s_add_u32 s49, s49, 32768
  s_mov_b32 s45, 0
  s_lshl_b32 s32, s44, 7
  s_add_u32 s32, s32, s46
  s_mul_i32 s33, s44, 221184
  s_add_u32 s33, s33, s47
  s_add_u32 s34, s45, s49
  s_add_u32 s35, s45, s48
  s_add_u32 s44, s44, 1
  s_cmp_eq_u32 s44, 9
  s_cselect_b32 s44, 0, s44
  s_add_u32 s45, s45, 49152
  s_cmp_eq_u32 s45, 147456
  s_cselect_b32 s45, 0, s45
  s_waitcnt lgkmcnt(0)
  s_mov_b32 m0, s34
  s_nop 0
  buffer_load_dwordx4 v44, s[12:15], s33 offen offset:0 lds
  buffer_load_dwordx4 v45, s[12:15], s33 offen offset:1024 lds
  buffer_load_dwordx4 v46, s[12:15], s33 offen offset:2048 lds
  buffer_load_dwordx4 v47, s[12:15], s33 offen offset:3072 lds
  s_add_u32 m0, s35, 0
  s_nop 0
  buffer_load_dwordx4 v36, s[8:11], s32 offen offset:0 lds
  buffer_load_dwordx4 v37, s[8:11], s32 offen offset:1024 lds
  buffer_load_dwordx4 v38, s[8:11], s32 offen offset:2048 lds
  buffer_load_dwordx4 v39, s[8:11], s32 offen offset:3072 lds
  s_add_u32 m0, s35, 4096
  s_nop 0
  buffer_load_dwordx4 v40, s[8:11], s32 offen offset:0 lds
  buffer_load_dwordx4 v41, s[8:11], s32 offen offset:1024 lds
  buffer_load_dwordx4 v42, s[8:11], s32 offen offset:2048 lds
  buffer_load_dwordx4 v43, s[8:11], s32 offen offset:3072 lds
  s_lshl_b32 s32, s44, 7
  s_add_u32 s32, s32, s46
  s_mul_i32 s33, s44, 221184
  s_add_u32 s33, s33, s47
  s_add_u32 s34, s45, s49
  s_add_u32 s35, s45, s48
  s_add_u32 s44, s44, 1
  s_cmp_eq_u32 s44, 9
  s_cselect_b32 s44, 0, s44
  s_add_u32 s45, s45, 49152
  s_cmp_eq_u32 s45, 147456
  s_cselect_b32 s45, 0, s45
  s_mov_b32 m0, s34
  s_nop 0
  buffer_load_dwordx4 v44, s[12:15], s33 offen offset:0 lds
  buffer_load_dwordx4 v45, s[12:15], s33 offen offset:1024 lds
  buffer_load_dwordx4 v46, s[12:15], s33 offen offset:2048 lds
  buffer_load_dwordx4 v47, s[12:15], s33 offen offset:3072 lds
  s_add_u32 m0, s35, 0
  s_nop 0
  buffer_load_dwordx4 v36, s[8:11], s32 offen offset:0 lds
  buffer_load_dwordx4 v37, s[8:11], s32 offen offset:1024 lds
  s_waitcnt vmcnt(6)
  s_barrier
  s_add_u32 m0, s35, 0
  s_nop 0
  buffer_load_dwordx4 v38, s[8:11], s32 offen offset:2048 lds
  buffer_load_dwordx4 v39, s[8:11], s32 offen offset:3072 lds
  s_add_u32 m0, s35, 4096
  s_nop 0
  buffer_load_dwordx4 v40, s[8:11], s32 offen offset:0 lds
  buffer_load_dwordx4 v41, s[8:11], s32 offen offset:1024 lds
  buffer_load_dwordx4 v42, s[8:11], s32 offen offset:2048 lds
  buffer_load_dwordx4 v43, s[8:11], s32 offen offset:3072 lds
  s_lshl_b32 s32, s44, 7
  s_add_u32 s32, s32, s46
  s_mul_i32 s33, s44, 221184
  s_add_u32 s33, s33, s47
  s_add_u32 s34, s45, s49
  s_add_u32 s35, s45, s48
  s_add_u32 s44, s44, 1
  s_cmp_eq_u32 s44, 9
  s_cselect_b32 s44, 0, s44
  s_add_u32 s45, s45, 49152
  s_cmp_eq_u32 s45, 147456
  s_cselect_b32 s45, 0, s45
  s_mov_b32 s43, 2
L_LD:
  s_mov_b32 m0, s34
  s_nop 0
  buffer_load_dwordx4 v44, s[12:15], s33 offen offset:0 lds
  buffer_load_dwordx4 v45, s[12:15], s33 offen offset:1024 lds
  buffer_load_dwordx4 v46, s[12:15], s33 offen offset:2048 lds
  buffer_load_dwordx4 v47, s[12:15], s33 offen offset:3072 lds
  s_add_u32 m0, s35, 0
  s_nop 0
  buffer_load_dwordx4 v36, s[8:11], s32 offen offset:0 lds
  buffer_load_dwordx4 v37, s[8:11], s32 offen offset:1024 lds
  buffer_load_dwordx4 v38, s[8:11], s32 offen offset:2048 lds
  buffer_load_dwordx4 v39, s[8:11], s32 offen offset:3072 lds
  s_add_u32 m0, s35, 4096
  s_nop 0
  buffer_load_dwordx4 v40, s[8:11], s32 offen offset:0 lds
  buffer_load_dwordx4 v41, s[8:11], s32 offen offset:1024 lds
  buffer_load_dwordx4 v42, s[8:11], s32 offen offset:2048 lds
  buffer_load_dwordx4 v43, s[8:11], s32 offen offset:3072 lds
  s_lshl_b32 s32, s44, 7
  s_add_u32 s32, s32, s46
  s_mul_i32 s33, s44, 221184
  s_add_u32 s33, s33, s47
  s_add_u32 s34, s45, s49
  s_add_u32 s35, s45, s48
  s_add_u32 s44, s44, 1
  s_cmp_eq_u32 s44, 9
  s_cselect_b32 s44, 0, s44
  s_add_u32 s45, s45, 49152
  s_cmp_eq_u32 s45, 147456
  s_cselect_b32 s45, 0, s45
  s_add_u32 s43, s43, 1
  s_cmp_lt_u32 s43, 9
  s_waitcnt vmcnt(12)
  s_barrier
  s_cbranch_scc1 L_LD
  s_lshl_b32 s32, s39, 6
  v_add_u32 v2, s32, v1
  v_mul_u32_u24 v3, 7282, v2
  v_lshrrev_b32 v3, 16, v3
  v_mul_u32_u24 v4, 9, v3
  v_sub_u32 v4, v2, v4
  v_mul_u32_u24 v3, 1152, v3
  v_lshl_add_u32 v3, v4, 7, v3
  s_mul_i32 s32, s38, 20736
  v_cmp_gt_u32 vcc, 162, v2
  v_cndmask_b32_e64 v3, 0, v3, vcc
  buffer_load_dword v255, v3, s[16:19], s32 offen
  v_and_b32 v2, 31, v1
  v_lshrrev_b32 v3, 5, v1
  v_lshlrev_b32 v3, 2, v3
  v_sub_u32 v2, v2, v3
  v_mov_b32 v3, 0xff61b1e6
  v_cmp_le_i32 vcc, 0, v2
  s_nop 1
  v_cndmask_b32_e64 v20, v3, 0, vcc
  v_cmp_le_i32 vcc, 1, v2
  s_nop 1
  v_cndmask_b32_e64 v21, v3, 0, vcc
  v_cmp_le_i32 vcc, 2, v2
  s_nop 1
  v_cndmask_b32_e64 v22, v3, 0, vcc
  v_cmp_le_i32 vcc, 3, v2
  s_nop 1
  v_cndmask_b32_e64 v23, v3, 0, vcc
  v_cmp_le_i32 vcc, 8, v2
  s_nop 1
  v_cndmask_b32_e64 v24, v3, 0, vcc
  v_cmp_le_i32 vcc, 9, v2
  s_nop 1
  v_cndmask_b32_e64 v25, v3, 0, vcc
  v_cmp_le_i32 vcc, 10, v2
  s_nop 1
  v_cndmask_b32_e64 v26, v3, 0, vcc
  v_cmp_le_i32 vcc, 11, v2
  s_nop 1
  v_cndmask_b32_e64 v27, v3, 0, vcc
  v_cmp_le_i32 vcc, 16, v2
  s_nop 1
  v_cndmask_b32_e64 v28, v3, 0, vcc
  v_cmp_le_i32 vcc, 17, v2
  s_nop 1
  v_cndmask_b32_e64 v29, v3, 0, vcc
  v_cmp_le_i32 vcc, 18, v2
  s_nop 1
  v_cndmask_b32_e64 v30, v3, 0, vcc
  v_cmp_le_i32 vcc, 19, v2
  s_nop 1
  v_cndmask_b32_e64 v31, v3, 0, vcc
  v_cmp_le_i32 vcc, 24, v2
  s_nop 1
  v_cndmask_b32_e64 v32, v3, 0, vcc
  v_cmp_le_i32 vcc, 25, v2
  s_nop 1
  v_cndmask_b32_e64 v33, v3, 0, vcc
  v_cmp_le_i32 vcc, 26, v2
  s_nop 1
  v_cndmask_b32_e64 v34, v3, 0, vcc
  v_cmp_le_i32 vcc, 27, v2
  s_nop 1
  v_cndmask_b32_e64 v35, v3, 0, vcc
  v_and_b32 v2, 31, v1
  v_lshrrev_b32 v3, 5, v1
  v_lshrrev_b32 v4, 2, v2
  v_lshrrev_b32 v5, 3, v2
  v_xor_b32 v4, v4, v5
  v_xor_b32 v4, v4, v3
  v_and_b32 v4, 1, v4
  v_lshlrev_b32 v4, 4, v4
  v_lshl_add_u32 v4, v2, 5, v4
  s_lshl_b32 s32, s56, 10
  v_add_u32 v240, s32, v4
  v_lshlrev_b32 v241, 3, v2
  v_add_u32 v241, 2048, v241
  v_bfe_u32 v4, v1, 2, 2
  v_lshl_add_u32 v4, v3, 2, v4
  v_mul_u32_u24 v4, 72, v4
  v_add_u32 v4, 2304, v4
  v_and_b32 v5, 3, v1
  v_lshlrev_b32 v6, 3, v5
  s_mul_i32 s32, s56, 40
  v_add3_u32 v6, v6, v4, s32
  v_add_u32 v7, 32, v4
  v_bfe_u32 v8, v1, 4, 1
  v_cmp_eq_u32 vcc, 1, v8
  v_lshrrev_b32 v9, 1, v5
  v_and_b32 v9, v9, v8
  v_cndmask_b32 v242, v6, v7, vcc
  v_cmp_eq_u32 vcc, 1, v9
  v_mov_b32 v7, 156672
  v_mov_b32 v8, -1
  v_cndmask_b32 v242, v242, v7, vcc
  v_cndmask_b32_e64 v243, v8, 0, vcc
  v_mul_u32_u24 v3, 7282, v1
  v_lshrrev_b32 v3, 16, v3
  v_mul_u32_u24 v4, 9, v3
  v_sub_u32 v4, v1, v4
  v_mul_u32_u24 v3, 1152, v3
  v_lshl_add_u32 v3, v4, 4, v3
  s_and_b32 s32, s30, 7
  s_mul_i32 s32, s32, 144
  v_add_u32 v180, s32, v3
  v_add_u32 v181, 7056, v180
  v_add_u32 v182, 14112, v180
  v_add_u32 v183, 21168, v180
  s_mul_i32 s32, s39, 21168
  s_mul_i32 s33, s39, 169344
  s_waitcnt vmcnt(1)
  s_barrier
  s_bitset0_b64 exec, 63
  s_add_u32 m0, s32, 0
  s_add_u32 s34, s33, 0
  buffer_load_dwordx4 v180, s[16:19], s34 offen offset:0 lds
  buffer_load_dwordx4 v181, s[16:19], s34 offen offset:1008 lds
  buffer_load_dwordx4 v182, s[16:19], s34 offen offset:2016 lds
  buffer_load_dwordx4 v183, s[16:19], s34 offen offset:3024 lds
  s_add_u32 m0, s32, 4032
  s_add_u32 s34, s33, 32256
  buffer_load_dwordx4 v180, s[16:19], s34 offen offset:0 lds
  buffer_load_dwordx4 v181, s[16:19], s34 offen offset:1008 lds
  buffer_load_dwordx4 v182, s[16:19], s34 offen offset:2016 lds
  buffer_load_dwordx4 v183, s[16:19], s34 offen offset:3024 lds
  s_mov_b64 exec, -1
  s_barrier
  s_bitset0_b64 exec, 63
  s_add_u32 m0, s32, 8064
  s_add_u32 s34, s33, 64512
  buffer_load_dwordx4 v180, s[16:19], s34 offen offset:0 lds
  buffer_load_dwordx4 v181, s[16:19], s34 offen offset:1008 lds
  buffer_load_dwordx4 v182, s[16:19], s34 offen offset:2016 lds
  buffer_load_dwordx4 v183, s[16:19], s34 offen offset:3024 lds
  s_add_u32 m0, s32, 12096
  s_add_u32 s34, s33, 96768
  buffer_load_dwordx4 v180, s[16:19], s34 offen offset:0 lds
  buffer_load_dwordx4 v181, s[16:19], s34 offen offset:1008 lds
  buffer_load_dwordx4 v182, s[16:19], s34 offen offset:2016 lds
  buffer_load_dwordx4 v183, s[16:19], s34 offen offset:3024 lds
  s_add_u32 m0, s32, 16128
  s_add_u32 s34, s33, 129024
  buffer_load_dwordx4 v180, s[16:19], s34 offen offset:0 lds
  buffer_load_dwordx4 v181, s[16:19], s34 offen offset:1008 lds
  buffer_load_dwordx4 v182, s[16:19], s34 offen offset:2016 lds
  s_cmp_eq_u32 s39, 3
  s_cbranch_scc0 L_WO_N
  s_mov_b64 exec, 0x3ffff
  buffer_load_dwordx4 v183, s[16:19], s34 offen offset:3024 lds
  s_branch L_WO_DONE
L_WO_N:
  buffer_load_dwordx4 v183, s[16:19], s34 offen offset:3024 lds
  s_add_u32 m0, s32, 20160
  s_add_u32 s34, s33, 161280
  buffer_load_dwordx4 v180, s[16:19], s34 offen offset:0 lds
L_WO_DONE:
  s_mov_b64 exec, -1
  v_mov_b32 v52, 0
  v_mov_b32 v68, 0
  v_mov_b32 v53, 0
  v_mov_b32 v69, 0
  v_mov_b32 v54, 0
  v_mov_b32 v70, 0
  v_mov_b32 v55, 0
  v_mov_b32 v71, 0
  v_mov_b32 v56, 0
  v_mov_b32 v72, 0
  v_mov_b32 v57, 0
  v_mov_b32 v73, 0
  v_mov_b32 v58, 0
  v_mov_b32 v74, 0
  v_mov_b32 v59, 0
  v_mov_b32 v75, 0
  v_mov_b32 v60, 0
  v_mov_b32 v76, 0
  v_mov_b32 v61, 0
  v_mov_b32 v77, 0
  v_mov_b32 v62, 0
  v_mov_b32 v78, 0
  v_mov_b32 v63, 0
  v_mov_b32 v79, 0
  v_mov_b32 v64, 0
  v_mov_b32 v80, 0
  v_mov_b32 v65, 0
  v_mov_b32 v81, 0
  v_mov_b32 v66, 0
  v_mov_b32 v82, 0
  v_mov_b32 v67, 0
  v_mov_b32 v83, 0
  v_lshlrev_b32 v184, 4, v1
  s_lshl_b32 s32, s39, 10
  v_add_u32 v184, s32, v184
  v_add_u32 v185, 82944, v184
  s_mul_i32 s33, s54, 36864
  s_barrier
  s_cmp_eq_u32 s29, 7
  s_cbranch_scc1 L_NOPUB
  ds_read_b128 v[140:143], v185 offset:32768
  ds_read_b128 v[144:147], v185 offset:28672
  ds_read_b128 v[148:151], v185 offset:24576
  ds_read_b128 v[152:155], v185 offset:20480
  ds_read_b128 v[156:159], v185 offset:16384
  ds_read_b128 v[160:163], v185 offset:12288
  ds_read_b128 v[164:167], v185 offset:8192
  ds_read_b128 v[168:171], v185 offset:4096
  ds_read_b128 v[172:175], v185 offset:0
  s_waitcnt lgkmcnt(8)
  s_add_u32 s34, s33, 32768
  buffer_store_dwordx4 v[140:143], v184, s[20:23], s34 offen sc1
  s_waitcnt lgkmcnt(7)
  s_add_u32 s34, s33, 28672
  buffer_store_dwordx4 v[144:147], v184, s[20:23], s34 offen sc1
  s_waitcnt lgkmcnt(6)
  s_add_u32 s34, s33, 24576
  buffer_store_dwordx4 v[148:151], v184, s[20:23], s34 offen sc1
  s_waitcnt lgkmcnt(5)
  s_add_u32 s34, s33, 20480
  buffer_store_dwordx4 v[152:155], v184, s[20:23], s34 offen sc1
  s_waitcnt lgkmcnt(4)
  s_add_u32 s34, s33, 16384
  buffer_store_dwordx4 v[156:159], v184, s[20:23], s34 offen sc1
L_NOPUB:
  s_branch L_P2
L_COMPUTE:
  v_and_b32 v2, 15, v1
  v_lshrrev_b32 v3, 4, v1
  v_lshrrev_b32 v4, 1, v2
  s_lshl_b32 s32, s31, 6
  v_add_u32 v5, s32, v2
  v_lshlrev_b32 v5, 7, v5
  v_xor_b32 v6, v3, v4
  v_lshlrev_b32 v7, 4, v6
  v_add_u32 v10, v5, v7
  v_xor_b32 v6, 4, v6
  v_lshlrev_b32 v7, 4, v6
  v_add_u32 v11, v5, v7
  v_bfe_u32 v2, v1, 2, 2
  v_and_b32 v4, 3, v1
  v_and_b32 v5, 1, v3
  v_lshl_add_u32 v5, v5, 2, v2
  v_lshlrev_b32 v5, 5, v5
  v_lshl_add_u32 v6, v3, 3, v2
  v_lshlrev_b32 v6, 8, v6
  v_add_u32 v6, 32768, v6
  v_lshlrev_b32 v7, 3, v4
  s_and_b32 s33, s30, 1
  s_lshl_b32 s33, s33, 3
  v_add3_u32 v7, v7, v5, s33
  v_add_u32 v8, 0, v7
  v_and_b32 v8, 255, v8
  v_add_u32 v12, v6, v8
  v_add_u32 v8, 40, v7
  v_and_b32 v8, 255, v8
  v_add_u32 v13, v6, v8
  v_add_u32 v8, 80, v7
  v_and_b32 v8, 255, v8
  v_add_u32 v14, v6, v8
  v_add_u32 v8, 120, v7
  v_and_b32 v8, 255, v8
  v_add_u32 v15, v6, v8
  v_add_u32 v8, 160, v7
  v_and_b32 v8, 255, v8
  v_add_u32 v16, v6, v8
  v_add_u32 v8, 200, v7
  v_and_b32 v8, 255, v8
  v_add_u32 v17, v6, v8
  v_min_u32 v8, 2, v4
  v_mul_u32_u24 v8, 80, v8
  v_add3_u32 v8, v8, v5, s33
  v_add_u32 v8, 32, v8
  v_and_b32 v8, 255, v8
  v_add_u32 v18, v6, v8
  v_and_b32 v2, 15, v1
  v_lshrrev_b32 v3, 4, v1
  v_and_b32 v4, 1, v3
  v_lshl_add_u32 v4, v4, 4, v2
  v_lshrrev_b32 v5, 2, v2
  v_lshrrev_b32 v6, 3, v2
  v_xor_b32 v5, v5, v6
  v_lshrrev_b32 v6, 1, v3
  v_xor_b32 v5, v5, v6
  v_and_b32 v5, 1, v5
  v_lshlrev_b32 v5, 4, v5
  v_lshl_add_u32 v5, v4, 5, v5
  s_mul_i32 s32, s31, 9216
  s_add_u32 s32, s32, 82944
  s_mul_i32 s33, s31, 4608
  s_add_u32 s33, s33, 119808
  v_add_u32 v244, s32, v5
  v_add_u32 v245, s33, v5
  v_mul_u32_u24 v6, 72, v2
  v_lshl_add_u32 v7, v3, 3, v6
  v_add_u32 v7, 2304, v7
  v_add_u32 v246, s32, v7
  v_lshlrev_b32 v7, 3, v2
  v_add_u32 v7, 2048, v7
  v_add_u32 v8, s33, v7
  v_add_u32 v9, s32, v7
  v_add_u32 v6, 2336, v6
  v_add_u32 v6, s32, v6
  v_mov_b32 v248, 128
  v_mov_b32 v249, 4608
  v_mov_b32 v250, 1.0
  v_mov_b32 v247, v9
  v_cmp_eq_u32 vcc, 0, v3
  v_mov_b32 v7, 2304
  v_mov_b32 v252, 0x3eae1a93
  v_cndmask_b32 v247, v247, v8, vcc
  v_cndmask_b32 v249, v249, v7, vcc
  v_cndmask_b32 v250, v250, v252, vcc
  v_cmp_eq_u32 vcc, 2, v3
  v_mov_b32 v7, 1152
  v_mov_b32 v253, v252
  v_cndmask_b32 v247, v247, v6, vcc
  v_cndmask_b32 v248, v248, v7, vcc
  v_mov_b32 v251, v250
  s_waitcnt lgkmcnt(0)
  s_cmp_lg_u32 s31, 3
  s_cbranch_scc1 L_NOCP
  s_getpc_b64 s[52:53]
L_PCREF:
  s_sub_u32 s52, s52, L_PCREF-concat_heads__sliding_block__sliding_block__prompt_kernel
  s_subb_u32 s53, s53, 0
  s_mul_i32 s32, s38, 640
  v_lshlrev_b32 v2, 7, v1
  v_add_u32 v2, s32, v2
  s_mov_b32 s33, L_END-concat_heads__sliding_block__sliding_block__prompt_kernel
  v_cmp_gt_u32 vcc, s33, v2
  s_and_b64 vcc, vcc, 31
  s_and_saveexec_b64 s[58:59], vcc
  s_cbranch_execz L_NOCP2
  global_load_dword v254, v2, s[52:53]
L_NOCP2:
  s_mov_b64 exec, s[58:59]
L_NOCP:
  s_cmp_lg_u32 s31, 0
  s_cbranch_scc1 L_NOG0
  s_lshl_b32 s32, s54, 8
  s_add_u32 s32, s32, 14155776
  s_lshl_b32 s33, s55, 12
  s_add_u32 s33, s33, 14221312
  v_mov_b32 v2, 0
  buffer_load_dword v236, v2, s[20:23], s32 offen sc1
  s_sub_u32 s32, s32, 256
  s_max_u32 s32, s32, 14155776
  buffer_load_dword v237, v2, s[20:23], s32 offen sc1
  buffer_load_dword v238, v2, s[20:23], s33 offen sc1
L_NOG0:
  v_mov_b32 v124, 0
  v_mov_b32 v125, 0
  v_mov_b32 v126, 0
  v_mov_b32 v127, 0
  v_mov_b32 v128, 0
  v_mov_b32 v129, 0
  v_mov_b32 v130, 0
  v_mov_b32 v131, 0
  v_mov_b32 v132, 0
  v_mov_b32 v133, 0
  v_mov_b32 v134, 0
  v_mov_b32 v135, 0
  v_mov_b32 v136, 0
  v_mov_b32 v137, 0
  v_mov_b32 v138, 0
  v_mov_b32 v139, 0
  v_mov_b32 v140, 0
  v_mov_b32 v141, 0
  v_mov_b32 v142, 0
  v_mov_b32 v143, 0
  v_mov_b32 v144, 0
  v_mov_b32 v145, 0
  v_mov_b32 v146, 0
  v_mov_b32 v147, 0
  v_mov_b32 v148, 0
  v_mov_b32 v149, 0
  v_mov_b32 v150, 0
  v_mov_b32 v151, 0
  v_mov_b32 v152, 0
  v_mov_b32 v153, 0
  v_mov_b32 v154, 0
  v_mov_b32 v155, 0
  v_mov_b32 v156, 0
  v_mov_b32 v157, 0
  v_mov_b32 v158, 0
  v_mov_b32 v159, 0
  v_mov_b32 v160, 0
  v_mov_b32 v161, 0
  v_mov_b32 v162, 0
  v_mov_b32 v163, 0
  v_mov_b32 v164, 0
  v_mov_b32 v165, 0
  v_mov_b32 v166, 0
  v_mov_b32 v167, 0
  v_mov_b32 v168, 0
  v_mov_b32 v169, 0
  v_mov_b32 v170, 0
  v_mov_b32 v171, 0
  v_mov_b32 v172, 0
  v_mov_b32 v173, 0
  v_mov_b32 v174, 0
  v_mov_b32 v175, 0
  v_mov_b32 v176, 0
  v_mov_b32 v177, 0
  v_mov_b32 v178, 0
  v_mov_b32 v179, 0
  v_mov_b32 v180, 0
  v_mov_b32 v181, 0
  v_mov_b32 v182, 0
  v_mov_b32 v183, 0
  v_mov_b32 v184, 0
  v_mov_b32 v185, 0
  v_mov_b32 v186, 0
  v_mov_b32 v187, 0
  v_mov_b32 v188, 0
  v_mov_b32 v189, 0
  v_mov_b32 v190, 0
  v_mov_b32 v191, 0
  v_mov_b32 v192, 0
  v_mov_b32 v193, 0
  v_mov_b32 v194, 0
  v_mov_b32 v195, 0
  v_mov_b32 v196, 0
  v_mov_b32 v197, 0
  v_mov_b32 v198, 0
  v_mov_b32 v199, 0
  v_mov_b32 v200, 0
  v_mov_b32 v201, 0
  v_mov_b32 v202, 0
  v_mov_b32 v203, 0
  v_mov_b32 v204, 0
  v_mov_b32 v205, 0
  v_mov_b32 v206, 0
  v_mov_b32 v207, 0
  v_mov_b32 v208, 0
  v_mov_b32 v209, 0
  v_mov_b32 v210, 0
  v_mov_b32 v211, 0
  v_mov_b32 v212, 0
  v_mov_b32 v213, 0
  v_mov_b32 v214, 0
  v_mov_b32 v215, 0
  v_mov_b32 v216, 0
  v_mov_b32 v217, 0
  v_mov_b32 v218, 0
  v_mov_b32 v219, 0
  v_mov_b32 v220, 0
  v_mov_b32 v221, 0
  v_mov_b32 v222, 0
  v_mov_b32 v223, 0
  v_mov_b32 v224, 0
  v_mov_b32 v225, 0
  v_mov_b32 v226, 0
  v_mov_b32 v227, 0
  v_mov_b32 v228, 0
  v_mov_b32 v229, 0
  v_mov_b32 v230, 0
  v_mov_b32 v231, 0
  v_mov_b32 v232, 0
  v_mov_b32 v233, 0
  v_mov_b32 v234, 0
  v_mov_b32 v235, 0
  v_and_b32 v2, 31, v1
  v_lshrrev_b32 v3, 5, v1
  v_lshlrev_b32 v3, 2, v3
  v_sub_u32 v2, v2, v3
  v_mov_b32 v3, 0xff61b1e6
  v_cmp_le_i32 vcc, 0, v2
  s_nop 1
  v_cndmask_b32_e64 v20, v3, 0, vcc
  v_cmp_le_i32 vcc, 1, v2
  s_nop 1
  v_cndmask_b32_e64 v21, v3, 0, vcc
  v_cmp_le_i32 vcc, 2, v2
  s_nop 1
  v_cndmask_b32_e64 v22, v3, 0, vcc
  v_cmp_le_i32 vcc, 3, v2
  s_nop 1
  v_cndmask_b32_e64 v23, v3, 0, vcc
  v_cmp_le_i32 vcc, 8, v2
  s_nop 1
  v_cndmask_b32_e64 v24, v3, 0, vcc
  v_cmp_le_i32 vcc, 9, v2
  s_nop 1
  v_cndmask_b32_e64 v25, v3, 0, vcc
  v_cmp_le_i32 vcc, 10, v2
  s_nop 1
  v_cndmask_b32_e64 v26, v3, 0, vcc
  v_cmp_le_i32 vcc, 11, v2
  s_nop 1
  v_cndmask_b32_e64 v27, v3, 0, vcc
  v_cmp_le_i32 vcc, 16, v2
  s_nop 1
  v_cndmask_b32_e64 v28, v3, 0, vcc
  v_cmp_le_i32 vcc, 17, v2
  s_nop 1
  v_cndmask_b32_e64 v29, v3, 0, vcc
  v_cmp_le_i32 vcc, 18, v2
  s_nop 1
  v_cndmask_b32_e64 v30, v3, 0, vcc
  v_cmp_le_i32 vcc, 19, v2
  s_nop 1
  v_cndmask_b32_e64 v31, v3, 0, vcc
  v_cmp_le_i32 vcc, 24, v2
  s_nop 1
  v_cndmask_b32_e64 v32, v3, 0, vcc
  v_cmp_le_i32 vcc, 25, v2
  s_nop 1
  v_cndmask_b32_e64 v33, v3, 0, vcc
  v_cmp_le_i32 vcc, 26, v2
  s_nop 1
  v_cndmask_b32_e64 v34, v3, 0, vcc
  v_cmp_le_i32 vcc, 27, v2
  s_nop 1
  v_cndmask_b32_e64 v35, v3, 0, vcc
  v_and_b32 v2, 31, v1
  v_lshrrev_b32 v3, 5, v1
  v_lshrrev_b32 v4, 2, v2
  v_lshrrev_b32 v5, 3, v2
  v_xor_b32 v4, v4, v5
  v_xor_b32 v4, v4, v3
  v_and_b32 v4, 1, v4
  v_lshlrev_b32 v4, 4, v4
  v_lshl_add_u32 v4, v2, 5, v4
  s_lshl_b32 s32, s56, 10
  v_add_u32 v240, s32, v4
  v_lshlrev_b32 v241, 3, v2
  v_add_u32 v241, 2048, v241
  v_bfe_u32 v4, v1, 2, 2
  v_lshl_add_u32 v4, v3, 2, v4
  v_mul_u32_u24 v4, 72, v4
  v_add_u32 v4, 2304, v4
  v_and_b32 v5, 3, v1
  v_lshlrev_b32 v6, 3, v5
  s_mul_i32 s32, s56, 40
  v_add3_u32 v6, v6, v4, s32
  v_add_u32 v7, 32, v4
  v_bfe_u32 v8, v1, 4, 1
  v_cmp_eq_u32 vcc, 1, v8
  v_lshrrev_b32 v9, 1, v5
  v_and_b32 v9, v9, v8
  v_cndmask_b32 v242, v6, v7, vcc
  v_cmp_eq_u32 vcc, 1, v9
  v_mov_b32 v7, 156672
  v_mov_b32 v8, -1
  v_cndmask_b32 v242, v242, v7, vcc
  v_cndmask_b32_e64 v243, v8, 0, vcc
  v_mov_b32 v4, 0x3f803f80
  v_mov_b32 v5, 0x3f803f80
  v_mul_u32_u24 v6, 576, v1
  v_add_u32 v6, 156672, v6
  s_mov_b64 s[58:59], exec
  s_mov_b64 exec, 15
  ds_write_b64 v6, v[4:5]
  s_mov_b64 exec, s[58:59]
  s_cmp_lg_u32 s31, 0
  s_cbranch_scc1 L_NOG1
  s_waitcnt vmcnt(0)
  v_add_u32 v236, 0x9e3779b1, v236
  v_add_u32 v237, 0x9e3779b1, v237
  v_add_u32 v238, 0x9e3779b1, v238
  v_mov_b32 v239, 0
  v_mov_b32 v6, 158720
  s_mov_b64 s[58:59], exec
  s_mov_b64 exec, 1
  ds_write_b128 v6, v[236:239]
  v_mov_b32 v236, 0
  v_mov_b32 v237, 0
  v_mov_b32 v238, 0
  v_mov_b32 v239, 0
  ds_write_b128 v6, v[236:239] offset:16
  s_mov_b64 exec, s[58:59]
L_NOG1:
  s_waitcnt lgkmcnt(0)
  s_barrier
  v_mov_b32 v236, -1
  v_mov_b32 v237, -1
  v_mov_b32 v238, -1
  v_mov_b32 v239, -1
  v_lshlrev_b32 v255, 4, v1
  s_lshl_b32 s46, s55, 18
  s_add_u32 s46, s46, 9437184
  s_lshl_b32 s32, s31, 16
  s_add_u32 s46, s46, s32
  s_lshl_b32 s32, s30, 10
  s_add_u32 s46, s46, s32
  s_lshl_b32 s47, s55, 15
  s_add_u32 s47, s47, 13631488
  s_lshl_b32 s32, s30, 1
  s_and_b32 s33, s31, 1
  s_add_u32 s32, s32, s33
  s_lshl_b32 s32, s32, 10
  s_add_u32 s47, s47, s32
  ds_read_b128 v[36:39], v10 offset:0
  ds_read_b64_tr_b16 v[52:53], v12 offset:0
  ds_read_b64_tr_b16 v[54:55], v12 offset:1024
  ds_read_b128 v[40:43], v10 offset:2048
  ds_read_b64_tr_b16 v[56:57], v13 offset:0
  ds_read_b64_tr_b16 v[58:59], v13 offset:1024
  ds_read_b128 v[44:47], v10 offset:4096
  ds_read_b64_tr_b16 v[60:61], v14 offset:0
  ds_read_b64_tr_b16 v[62:63], v14 offset:1024
  ds_read_b128 v[48:51], v10 offset:6144
  ds_read_b64_tr_b16 v[64:65], v15 offset:0
  ds_read_b64_tr_b16 v[66:67], v15 offset:1024
  ds_read_b64_tr_b16 v[68:69], v16 offset:0
  ds_read_b64_tr_b16 v[70:71], v16 offset:1024
  ds_read_b64_tr_b16 v[72:73], v17 offset:0
  ds_read_b64_tr_b16 v[74:75], v17 offset:1024
  ds_read_b64_tr_b16 v[76:77], v18 offset:0
  ds_read_b64_tr_b16 v[78:79], v18 offset:1024
  s_mov_b32 s43, 0
  s_mov_b32 s45, 0
L_GEMM:
  s_cmp_lt_u32 s43, 7
  s_cbranch_scc1 L_GEMM_NC
  buffer_store_dwordx4 v[236:239], v255, s[20:23], s46 offen sc1
  s_add_u32 s46, s46, 16384
  buffer_store_dwordx4 v[236:239], v255, s[20:23], s46 offen sc1
  s_add_u32 s46, s46, 16384
  s_cmp_eq_u32 s43, 8
  s_cbranch_scc1 L_GEMM_NC
  buffer_store_dwordx4 v[236:239], v255, s[20:23], s47 offen sc1
L_GEMM_NC:
  s_waitcnt lgkmcnt(0)
  v_mfma_f32_16x16x32_bf16 v[124:127], v[52:55], v[36:39], v[124:127]
  ds_read_b128 v[80:83], v11 offset:0
  v_mfma_f32_16x16x32_bf16 v[152:155], v[52:55], v[40:43], v[152:155]
  ds_read_b64_tr_b16 v[96:97], v12 offset:8192
  v_mfma_f32_16x16x32_bf16 v[180:183], v[52:55], v[44:47], v[180:183]
  ds_read_b64_tr_b16 v[98:99], v12 offset:9216
  v_mfma_f32_16x16x32_bf16 v[208:211], v[52:55], v[48:51], v[208:211]
  ds_read_b128 v[84:87], v11 offset:2048
  v_mfma_f32_16x16x32_bf16 v[128:131], v[56:59], v[36:39], v[128:131]
  ds_read_b64_tr_b16 v[100:101], v13 offset:8192
  v_mfma_f32_16x16x32_bf16 v[156:159], v[56:59], v[40:43], v[156:159]
  ds_read_b64_tr_b16 v[102:103], v13 offset:9216
  v_mfma_f32_16x16x32_bf16 v[184:187], v[56:59], v[44:47], v[184:187]
  ds_read_b128 v[88:91], v11 offset:4096
  v_mfma_f32_16x16x32_bf16 v[212:215], v[56:59], v[48:51], v[212:215]
  ds_read_b64_tr_b16 v[104:105], v14 offset:8192
  v_mfma_f32_16x16x32_bf16 v[132:135], v[60:63], v[36:39], v[132:135]
  ds_read_b64_tr_b16 v[106:107], v14 offset:9216
  v_mfma_f32_16x16x32_bf16 v[160:163], v[60:63], v[40:43], v[160:163]
  ds_read_b128 v[92:95], v11 offset:6144
  v_mfma_f32_16x16x32_bf16 v[188:191], v[60:63], v[44:47], v[188:191]
  ds_read_b64_tr_b16 v[108:109], v15 offset:8192
  v_mfma_f32_16x16x32_bf16 v[216:219], v[60:63], v[48:51], v[216:219]
  ds_read_b64_tr_b16 v[110:111], v15 offset:9216
  v_mfma_f32_16x16x32_bf16 v[136:139], v[64:67], v[36:39], v[136:139]
  ds_read_b64_tr_b16 v[112:113], v16 offset:8192
  v_mfma_f32_16x16x32_bf16 v[164:167], v[64:67], v[40:43], v[164:167]
  ds_read_b64_tr_b16 v[114:115], v16 offset:9216
  v_mfma_f32_16x16x32_bf16 v[192:195], v[64:67], v[44:47], v[192:195]
  ds_read_b64_tr_b16 v[116:117], v17 offset:8192
  v_mfma_f32_16x16x32_bf16 v[220:223], v[64:67], v[48:51], v[220:223]
  ds_read_b64_tr_b16 v[118:119], v17 offset:9216
  v_mfma_f32_16x16x32_bf16 v[140:143], v[68:71], v[36:39], v[140:143]
  ds_read_b64_tr_b16 v[120:121], v18 offset:8192
  v_mfma_f32_16x16x32_bf16 v[168:171], v[68:71], v[40:43], v[168:171]
  ds_read_b64_tr_b16 v[122:123], v18 offset:9216
  v_mfma_f32_16x16x32_bf16 v[196:199], v[68:71], v[44:47], v[196:199]
  s_add_u32 s45, s45, 1
  v_mfma_f32_16x16x32_bf16 v[224:227], v[68:71], v[48:51], v[224:227]
  s_cmp_eq_u32 s45, 3
  v_mfma_f32_16x16x32_bf16 v[144:147], v[72:75], v[36:39], v[144:147]
  s_mov_b32 s32, 49152
  v_mfma_f32_16x16x32_bf16 v[172:175], v[72:75], v[40:43], v[172:175]
  s_cselect_b32 s32, 4294868992, s32
  v_mfma_f32_16x16x32_bf16 v[200:203], v[72:75], v[44:47], v[200:203]
  s_cselect_b32 s45, 0, s45
  v_mfma_f32_16x16x32_bf16 v[228:231], v[72:75], v[48:51], v[228:231]
  v_mfma_f32_16x16x32_bf16 v[148:151], v[76:79], v[36:39], v[148:151]
  v_mfma_f32_16x16x32_bf16 v[176:179], v[76:79], v[40:43], v[176:179]
  v_mfma_f32_16x16x32_bf16 v[204:207], v[76:79], v[44:47], v[204:207]
  v_mfma_f32_16x16x32_bf16 v[232:235], v[76:79], v[48:51], v[232:235]
  s_waitcnt lgkmcnt(0)
  s_barrier
  v_mfma_f32_16x16x32_bf16 v[124:127], v[96:99], v[80:83], v[124:127]
  v_add_u32 v10, s32, v10
  v_add_u32 v12, s32, v12
  v_mfma_f32_16x16x32_bf16 v[152:155], v[96:99], v[84:87], v[152:155]
  ds_read_b128 v[36:39], v10 offset:0
  ds_read_b64_tr_b16 v[52:53], v12 offset:0
  v_mfma_f32_16x16x32_bf16 v[180:183], v[96:99], v[88:91], v[180:183]
  ds_read_b64_tr_b16 v[54:55], v12 offset:1024
  v_add_u32 v13, s32, v13
  v_mfma_f32_16x16x32_bf16 v[208:211], v[96:99], v[92:95], v[208:211]
  ds_read_b128 v[40:43], v10 offset:2048
  ds_read_b64_tr_b16 v[56:57], v13 offset:0
  v_mfma_f32_16x16x32_bf16 v[128:131], v[100:103], v[80:83], v[128:131]
  ds_read_b64_tr_b16 v[58:59], v13 offset:1024
  v_add_u32 v14, s32, v14
  v_mfma_f32_16x16x32_bf16 v[156:159], v[100:103], v[84:87], v[156:159]
  ds_read_b128 v[44:47], v10 offset:4096
  ds_read_b64_tr_b16 v[60:61], v14 offset:0
  v_mfma_f32_16x16x32_bf16 v[184:187], v[100:103], v[88:91], v[184:187]
  ds_read_b64_tr_b16 v[62:63], v14 offset:1024
  v_mfma_f32_16x16x32_bf16 v[212:215], v[100:103], v[92:95], v[212:215]
  ds_read_b128 v[48:51], v10 offset:6144
  v_mfma_f32_16x16x32_bf16 v[132:135], v[104:107], v[80:83], v[132:135]
  v_add_u32 v15, s32, v15
  v_mfma_f32_16x16x32_bf16 v[160:163], v[104:107], v[84:87], v[160:163]
  ds_read_b64_tr_b16 v[64:65], v15 offset:0
  v_mfma_f32_16x16x32_bf16 v[188:191], v[104:107], v[88:91], v[188:191]
  ds_read_b64_tr_b16 v[66:67], v15 offset:1024
  v_mfma_f32_16x16x32_bf16 v[216:219], v[104:107], v[92:95], v[216:219]
  v_add_u32 v16, s32, v16
  v_mfma_f32_16x16x32_bf16 v[136:139], v[108:111], v[80:83], v[136:139]
  ds_read_b64_tr_b16 v[68:69], v16 offset:0
  v_mfma_f32_16x16x32_bf16 v[164:167], v[108:111], v[84:87], v[164:167]
  ds_read_b64_tr_b16 v[70:71], v16 offset:1024
  v_mfma_f32_16x16x32_bf16 v[192:195], v[108:111], v[88:91], v[192:195]
  v_add_u32 v17, s32, v17
  v_mfma_f32_16x16x32_bf16 v[220:223], v[108:111], v[92:95], v[220:223]
  ds_read_b64_tr_b16 v[72:73], v17 offset:0
  v_mfma_f32_16x16x32_bf16 v[140:143], v[112:115], v[80:83], v[140:143]
  ds_read_b64_tr_b16 v[74:75], v17 offset:1024
  v_mfma_f32_16x16x32_bf16 v[168:171], v[112:115], v[84:87], v[168:171]
  v_add_u32 v18, s32, v18
  v_mfma_f32_16x16x32_bf16 v[196:199], v[112:115], v[88:91], v[196:199]
  ds_read_b64_tr_b16 v[76:77], v18 offset:0
  v_mfma_f32_16x16x32_bf16 v[224:227], v[112:115], v[92:95], v[224:227]
  ds_read_b64_tr_b16 v[78:79], v18 offset:1024
  v_mfma_f32_16x16x32_bf16 v[144:147], v[116:119], v[80:83], v[144:147]
  v_add_u32 v11, s32, v11
  v_mfma_f32_16x16x32_bf16 v[172:175], v[116:119], v[84:87], v[172:175]
  s_add_u32 s43, s43, 1
  v_mfma_f32_16x16x32_bf16 v[200:203], v[116:119], v[88:91], v[200:203]
  s_cmp_lt_u32 s43, 9
  v_mfma_f32_16x16x32_bf16 v[228:231], v[116:119], v[92:95], v[228:231]
  v_mfma_f32_16x16x32_bf16 v[148:151], v[120:123], v[80:83], v[148:151]
  v_mfma_f32_16x16x32_bf16 v[176:179], v[120:123], v[84:87], v[176:179]
  v_mfma_f32_16x16x32_bf16 v[204:207], v[120:123], v[88:91], v[204:207]
  v_mfma_f32_16x16x32_bf16 v[232:235], v[120:123], v[92:95], v[232:235]
  s_cbranch_scc1 L_GEMM
  s_nop 3
  v_cvt_pk_bf16_f32 v84, v132, v133
  v_cvt_pk_bf16_f32 v86, v160, v161
  v_cvt_pk_bf16_f32 v85, v134, v135
  v_cvt_pk_bf16_f32 v87, v162, v163
  v_cvt_pk_bf16_f32 v88, v188, v189
  v_cvt_pk_bf16_f32 v90, v216, v217
  v_cvt_pk_bf16_f32 v89, v190, v191
  v_cvt_pk_bf16_f32 v91, v218, v219
  v_cvt_pk_bf16_f32 v92, v136, v137
  v_cvt_pk_bf16_f32 v94, v164, v165
  v_cvt_pk_bf16_f32 v93, v138, v139
  v_cvt_pk_bf16_f32 v95, v166, v167
  v_cvt_pk_bf16_f32 v96, v192, v193
  v_cvt_pk_bf16_f32 v98, v220, v221
  v_cvt_pk_bf16_f32 v97, v194, v195
  v_cvt_pk_bf16_f32 v99, v222, v223
  v_cvt_pk_bf16_f32 v100, v140, v141
  v_cvt_pk_bf16_f32 v101, v142, v143
  v_cvt_pk_bf16_f32 v102, v168, v169
  v_cvt_pk_bf16_f32 v103, v170, v171
  v_cvt_pk_bf16_f32 v104, v196, v197
  v_cvt_pk_bf16_f32 v105, v198, v199
  v_cvt_pk_bf16_f32 v106, v224, v225
  v_cvt_pk_bf16_f32 v107, v226, v227
  v_cvt_pk_bf16_f32 v108, v144, v145
  v_cvt_pk_bf16_f32 v109, v146, v147
  v_cvt_pk_bf16_f32 v110, v172, v173
  v_cvt_pk_bf16_f32 v111, v174, v175
  v_cvt_pk_bf16_f32 v112, v200, v201
  v_cvt_pk_bf16_f32 v113, v202, v203
  v_cvt_pk_bf16_f32 v114, v228, v229
  v_cvt_pk_bf16_f32 v115, v230, v231
  v_permlane16_swap_b32 v84, v86
  v_permlane16_swap_b32 v85, v87
  ds_write_b64 v246, v[100:101] offset:0
  ds_write_b64 v246, v[102:103] offset:1152
  v_permlane16_swap_b32 v88, v90
  v_permlane16_swap_b32 v89, v91
  ds_write_b64 v246, v[104:105] offset:4608
  ds_write_b64 v246, v[106:107] offset:5760
  v_permlane16_swap_b32 v92, v94
  v_permlane16_swap_b32 v93, v95
  ds_write_b64 v246, v[108:109] offset:40
  ds_write_b64 v246, v[110:111] offset:1192
  v_permlane16_swap_b32 v96, v98
  v_permlane16_swap_b32 v97, v99
  ds_write_b64 v246, v[112:113] offset:4648
  ds_write_b64 v246, v[114:115] offset:5800
  v_pk_mul_f32 v[148:149], v[148:149], v[250:251]
  v_pk_mul_f32 v[150:151], v[150:151], v[250:251]
  ds_write_b128 v244, v[84:87] offset:0
  v_pk_mul_f32 v[176:177], v[176:177], v[250:251]
  v_pk_mul_f32 v[178:179], v[178:179], v[250:251]
  ds_write_b128 v244, v[88:91] offset:4608
  v_pk_mul_f32 v[204:205], v[204:205], v[250:251]
  v_pk_mul_f32 v[206:207], v[206:207], v[250:251]
  ds_write_b128 v244, v[92:95] offset:1024
  v_pk_mul_f32 v[232:233], v[232:233], v[250:251]
  v_pk_mul_f32 v[234:235], v[234:235], v[250:251]
  ds_write_b128 v244, v[96:99] offset:5632
  v_add_u32 v2, v247, v248
  v_add_u32 v3, v247, v249
  v_cvt_pk_bf16_f32 v116, v148, v149
  v_cvt_pk_bf16_f32 v117, v150, v151
  v_cvt_pk_bf16_f32 v118, v176, v177
  v_cvt_pk_bf16_f32 v119, v178, v179
  v_cvt_pk_bf16_f32 v120, v204, v205
  v_cvt_pk_bf16_f32 v121, v206, v207
  v_cvt_pk_bf16_f32 v122, v232, v233
  v_cvt_pk_bf16_f32 v123, v234, v235
  v_add_u32 v4, v3, v248
  s_mov_b64 s[58:59], exec
  s_mov_b32 exec_hi, 0x0000ffff
  ds_write_b64 v247, v[116:117]
  ds_write_b64 v2, v[118:119]
  ds_write_b64 v3, v[120:121]
  ds_write_b64 v4, v[122:123]
  s_mov_b64 exec, s[58:59]
  v_pk_mul_f32 v[124:125], v[124:125], v[252:253]
  v_pk_mul_f32 v[126:127], v[126:127], v[252:253]
  v_pk_mul_f32 v[128:129], v[128:129], v[252:253]
  v_pk_mul_f32 v[130:131], v[130:131], v[252:253]
  v_pk_mul_f32 v[152:153], v[152:153], v[252:253]
  v_pk_mul_f32 v[154:155], v[154:155], v[252:253]
  v_pk_mul_f32 v[156:157], v[156:157], v[252:253]
  v_pk_mul_f32 v[158:159], v[158:159], v[252:253]
  v_pk_mul_f32 v[180:181], v[180:181], v[252:253]
  v_pk_mul_f32 v[182:183], v[182:183], v[252:253]
  v_pk_mul_f32 v[184:185], v[184:185], v[252:253]
  v_pk_mul_f32 v[186:187], v[186:187], v[252:253]
  v_pk_mul_f32 v[208:209], v[208:209], v[252:253]
  v_pk_mul_f32 v[210:211], v[210:211], v[252:253]
  v_pk_mul_f32 v[212:213], v[212:213], v[252:253]
  v_pk_mul_f32 v[214:215], v[214:215], v[252:253]
  s_waitcnt lgkmcnt(0)
  s_barrier
  v_cvt_pk_bf16_f32 v84, v124, v125
  v_cvt_pk_bf16_f32 v86, v152, v153
  v_cvt_pk_bf16_f32 v85, v126, v127
  v_cvt_pk_bf16_f32 v87, v154, v155
  v_cvt_pk_bf16_f32 v88, v180, v181
  v_cvt_pk_bf16_f32 v90, v208, v209
  v_cvt_pk_bf16_f32 v89, v182, v183
  v_cvt_pk_bf16_f32 v91, v210, v211
  v_cvt_pk_bf16_f32 v92, v128, v129
  v_cvt_pk_bf16_f32 v94, v156, v157
  v_cvt_pk_bf16_f32 v93, v130, v131
  v_cvt_pk_bf16_f32 v95, v158, v159
  v_cvt_pk_bf16_f32 v96, v184, v185
  v_cvt_pk_bf16_f32 v98, v212, v213
  v_cvt_pk_bf16_f32 v97, v186, v187
  v_cvt_pk_bf16_f32 v99, v214, v215
  v_mov_b32 v52, 0
  v_mov_b32 v53, 0
  v_mov_b32 v54, 0
  v_mov_b32 v55, 0
  v_mov_b32 v56, 0
  v_mov_b32 v57, 0
  v_mov_b32 v58, 0
  v_mov_b32 v59, 0
  v_permlane16_swap_b32 v84, v86
  v_permlane16_swap_b32 v85, v87
  v_mov_b32 v60, 0
  v_mov_b32 v61, 0
  v_mov_b32 v62, 0
  v_mov_b32 v63, 0
  ds_write_b128 v245, v[84:87] offset:0
  v_permlane16_swap_b32 v88, v90
  v_permlane16_swap_b32 v89, v91
  v_mov_b32 v64, 0
  v_mov_b32 v65, 0
  v_mov_b32 v66, 0
  v_mov_b32 v67, 0
  ds_write_b128 v245, v[88:91] offset:2304
  v_permlane16_swap_b32 v92, v94
  v_permlane16_swap_b32 v93, v95
  v_mov_b32 v68, 0
  v_mov_b32 v69, 0
  v_mov_b32 v70, 0
  v_mov_b32 v71, 0
  ds_write_b128 v245, v[92:95] offset:1024
  v_permlane16_swap_b32 v96, v98
  v_permlane16_swap_b32 v97, v99
  v_mov_b32 v72, 0
  v_mov_b32 v73, 0
  v_mov_b32 v74, 0
  v_mov_b32 v75, 0
  ds_write_b128 v245, v[96:99] offset:3328
  v_mov_b32 v76, 0
  v_mov_b32 v77, 0
  v_mov_b32 v78, 0
  v_mov_b32 v79, 0
  v_mov_b32 v80, 0
  v_mov_b32 v81, 0
  v_mov_b32 v82, 0
  v_mov_b32 v83, 0
L_P2:
  v_mov_b32 v2, 158720
  ds_read_b128 v[236:239], v2
  s_waitcnt lgkmcnt(0)
  s_barrier
  v_readfirstlane_b32 s41, v236
  v_readfirstlane_b32 s40, v237
  v_readfirstlane_b32 s42, v238
  v_bfe_u32 v188, v1, 4, 1
  v_lshlrev_b32 v188, 14, v188
  v_and_b32 v6, 15, v1
  v_lshl_add_u32 v188, v6, 4, v188
  v_lshrrev_b32 v6, 5, v1
  v_lshl_add_u32 v188, v6, 8, v188
  v_lshlrev_b32 v189, 2, v1
  s_mul_i32 s32, s57, 2304
  s_add_u32 s32, s32, 119808
  v_add_u32 v4, s32, v240
  v_add_u32 v5, s32, v241
  ds_read_b128 v[36:39], v4
  ds_read_b64 v[40:41], v5
  s_mul_i32 s32, s66, 2304
  s_add_u32 s32, s32, 119808
  v_add_u32 v4, s32, v240
  v_add_u32 v5, s32, v241
  ds_read_b128 v[44:47], v4
  ds_read_b64 v[48:49], v5
  s_cmp_eq_u32 s56, 0
  s_cselect_b32 s32, -1, 0
  s_cselect_b32 s33, 0, -1
  v_cmp_gt_u32 vcc, 32, v1
  v_mov_b32 v2, s32
  v_mov_b32 v3, s33
  v_cndmask_b32_e64 v2, 0, v2, vcc
  v_cndmask_b32_e64 v3, 0, v3, vcc
  v_mov_b32 v130, 0
  v_mov_b32 v131, 0
  v_mov_b32 v42, 0
  v_mov_b32 v43, 0
  v_mov_b32 v50, 0
  v_mov_b32 v51, 0
  s_waitcnt lgkmcnt(0)
  v_and_b32 v40, v40, v2
  v_and_b32 v41, v41, v3
  v_and_b32 v48, v48, v2
  v_and_b32 v49, v49, v3
  v_mov_b32 v2, 158740
  v_mov_b32 v3, 1
  s_mov_b64 s[58:59], exec
  s_mov_b64 exec, 1
  ds_add_u32 v2, v3
  s_mov_b64 exec, s[58:59]
  s_mov_b32 s51, 0
  s_mov_b32 s67, 0
  s_mov_b32 s61, 2
  s_mov_b32 s67, 5
  s_cmp_lt_u32 s31, 4
  s_cbranch_scc1 L_HS2
  s_mov_b32 s67, 0
  s_mov_b32 s61, 4
  s_cmp_eq_u32 s29, 7
  s_cbranch_scc1 L_HS1
  s_mul_i32 s33, s54, 36864
  s_add_u32 s34, s33, 12288
  buffer_store_dwordx4 v[160:163], v184, s[20:23], s34 offen sc1
  s_add_u32 s34, s33, 8192
  buffer_store_dwordx4 v[164:167], v184, s[20:23], s34 offen sc1
  s_add_u32 s34, s33, 4096
  buffer_store_dwordx4 v[168:171], v184, s[20:23], s34 offen sc1
  s_add_u32 s34, s33, 0
  buffer_store_dwordx4 v[172:175], v184, s[20:23], s34 offen sc1
L_HS1:
  s_setprio 1
L_HS2:
  s_mov_b32 s32, 0
  s_add_u32 s32, s32, 82944
  v_add_u32 v10, s32, v240
  v_add_u32 v11, s32, v241
  v_and_b32 v12, s32, v243
  v_add_u32 v12, v242, v12
  v_mov_b32 v14, 0x1200
  v_and_b32 v13, v14, v243
  s_add_u32 s50, s57, 1
  s_call_b64 s[52:53], L_RUNA
  s_mov_b32 s32, 0
  s_add_u32 s32, s32, 82944
  v_add_u32 v10, s32, v240
  v_add_u32 v11, s32, v241
  v_and_b32 v12, s32, v243
  v_add_u32 v12, v242, v12
  v_mov_b32 v14, 0x1200
  v_and_b32 v13, v14, v243
  s_sub_u32 s50, 8, s57
  s_call_b64 s[52:53], L_RUNB
  s_cmp_eq_u32 s29, 0
  s_cbranch_scc1 L_FINAL0
  v_mov_b32 v4, 0xff61b1e6
  v_sub_f32 v20, v4, v20
  v_sub_f32 v21, v4, v21
  v_sub_f32 v22, v4, v22
  v_sub_f32 v23, v4, v23
  v_sub_f32 v24, v4, v24
  v_sub_f32 v25, v4, v25
  v_sub_f32 v26, v4, v26
  v_sub_f32 v27, v4, v27
  v_sub_f32 v28, v4, v28
  v_sub_f32 v29, v4, v29
  v_sub_f32 v30, v4, v30
  v_sub_f32 v31, v4, v31
  v_sub_f32 v32, v4, v32
  v_sub_f32 v33, v4, v33
  v_sub_f32 v34, v4, v34
  v_sub_f32 v35, v4, v35
  s_cmp_lt_u32 s31, 4
  s_cbranch_scc1 L_H5DONE
  v_mov_b32 v2, 158740
  s_mov_b32 s60, 0
L_WQ:
  ds_read_b32 v3, v2
  s_add_u32 s60, s60, 1
  s_waitcnt lgkmcnt(0)
  v_readfirstlane_b32 s32, v3
  s_cmp_ge_u32 s32, 8
  s_cbranch_scc1 L_WQ_OK
  s_cmp_lt_u32 s60, 20000000
  s_cbranch_scc1 L_WQ
L_WQ_OK:
  v_add_u32 v185, 119808, v184
  s_waitcnt vmcnt(8)
  ds_write_b128 v185, v[140:143] offset:32768
  s_waitcnt vmcnt(7)
  ds_write_b128 v185, v[144:147] offset:28672
  s_waitcnt vmcnt(6)
  ds_write_b128 v185, v[148:151] offset:24576
  s_waitcnt vmcnt(5)
  ds_write_b128 v185, v[152:155] offset:20480
  s_waitcnt vmcnt(4)
  ds_write_b128 v185, v[156:159] offset:16384
  s_waitcnt vmcnt(3)
  ds_write_b128 v185, v[160:163] offset:12288
  s_waitcnt vmcnt(2)
  ds_write_b128 v185, v[164:167] offset:8192
  s_waitcnt vmcnt(1)
  ds_write_b128 v185, v[168:171] offset:4096
  s_waitcnt vmcnt(0)
  ds_write_b128 v185, v[172:175] offset:0
  s_waitcnt lgkmcnt(0)
  v_mov_b32 v2, 158736
  v_mov_b32 v3, 1
  s_mov_b64 s[58:59], exec
  s_mov_b64 exec, 1
  ds_add_u32 v2, v3
  s_mov_b64 exec, s[58:59]
  s_cmp_lg_u32 s31, 4
  s_cbranch_scc1 L_H5DONE
  s_sub_u32 s32, s54, 1
  s_lshl_b32 s32, s32, 8
  s_add_u32 s32, s32, 14155776
  v_mov_b32 v2, 0
  v_mov_b32 v3, s40
  s_mov_b64 s[58:59], exec
  s_mov_b64 exec, 1
  buffer_store_dword v3, v2, s[20:23], s32 offen sc1
  s_mov_b64 exec, s[58:59]
L_H5DONE:
  v_mov_b32 v2, 158736
  s_mov_b32 s60, 0
L_W1:
  ds_read_b32 v3, v2
  s_add_u32 s60, s60, 1
  s_waitcnt lgkmcnt(0)
  v_readfirstlane_b32 s32, v3
  s_cmp_ge_u32 s32, 4
  s_cbranch_scc1 L_W1_OK
  s_cmp_lt_u32 s60, 20000000
  s_cbranch_scc1 L_W1
L_W1_OK:
  s_mov_b32 s36, 7
  s_mul_i32 s32, s36, 4608
  s_add_u32 s32, s32, 119808
  v_add_u32 v10, s32, v240
  v_add_u32 v11, s32, v241
  v_and_b32 v12, s32, v243
  v_add_u32 v12, v242, v12
  v_mov_b32 v14, 0xffffee00
  v_and_b32 v13, v14, v243
  s_add_u32 s50, s57, 1
  s_call_b64 s[52:53], L_RUNB
  s_nop 7
  s_nop 3
  v_max3_f32 v2, |v68|, |v69|, |v70|
  v_max3_f32 v2, v2, |v71|, |v72|
  v_max3_f32 v2, v2, |v73|, |v74|
  v_max3_f32 v2, v2, |v75|, |v76|
  v_max3_f32 v2, v2, |v77|, |v78|
  v_max_f32_e64 v2, v2, |v79|
  v_mov_b32 v3, 0x21800000
  v_mov_b32 v4, 0x5d800000
  v_mov_b32 v5, 0x7f000000
  v_cmp_nge_f32 vcc, v80, v3
  v_cmp_nle_f32 s[62:63], v80, v4
  s_or_b64 vcc, vcc, s[62:63]
  v_cmp_nlt_f32 s[62:63], v2, v5
  s_or_b64 vcc, vcc, s[62:63]
  s_cmp_eq_u64 vcc, 0
  s_cbranch_scc1 L_SAFEB1
  s_mov_b32 s44, s66
  v_swap_b32 v36, v44
  v_swap_b32 v37, v45
  v_swap_b32 v38, v46
  v_swap_b32 v39, v47
  v_swap_b32 v40, v48
  v_swap_b32 v41, v49
  v_swap_b32 v42, v50
  v_swap_b32 v43, v51
  v_swap_b32 v52, v68
  v_swap_b32 v53, v69
  v_swap_b32 v54, v70
  v_swap_b32 v55, v71
  v_swap_b32 v56, v72
  v_swap_b32 v57, v73
  v_swap_b32 v58, v74
  v_swap_b32 v59, v75
  v_swap_b32 v60, v76
  v_swap_b32 v61, v77
  v_swap_b32 v62, v78
  v_swap_b32 v63, v79
  v_swap_b32 v64, v80
  v_swap_b32 v65, v81
  v_swap_b32 v66, v82
  v_swap_b32 v67, v83
  s_call_b64 s[52:53], L_FB
  v_swap_b32 v36, v44
  v_swap_b32 v37, v45
  v_swap_b32 v38, v46
  v_swap_b32 v39, v47
  v_swap_b32 v40, v48
  v_swap_b32 v41, v49
  v_swap_b32 v42, v50
  v_swap_b32 v43, v51
  v_swap_b32 v52, v68
  v_swap_b32 v53, v69
  v_swap_b32 v54, v70
  v_swap_b32 v55, v71
  v_swap_b32 v56, v72
  v_swap_b32 v57, v73
  v_swap_b32 v58, v74
  v_swap_b32 v59, v75
  v_swap_b32 v60, v76
  v_swap_b32 v61, v77
  v_swap_b32 v62, v78
  v_swap_b32 v63, v79
  v_swap_b32 v64, v80
  v_swap_b32 v65, v81
  v_swap_b32 v66, v82
  v_swap_b32 v67, v83
L_SAFEB1:
  v_rcp_f32 v4, v80
  s_lshl_b32 s32, s66, 15
  s_add_u32 s33, s32, s6
  s_lshl_b32 s32, s66, 7
  s_add_u32 s34, s32, s7
  v_mul_f32 v68, v68, v4
  v_mul_f32 v69, v69, v4
  v_mul_f32 v70, v70, v4
  v_mul_f32 v71, v71, v4
  v_mul_f32 v72, v72, v4
  v_mul_f32 v73, v73, v4
  v_mul_f32 v74, v74, v4
  v_mul_f32 v75, v75, v4
  v_mul_f32 v76, v76, v4
  v_mul_f32 v77, v77, v4
  v_mul_f32 v78, v78, v4
  v_mul_f32 v79, v79, v4
  v_cvt_pk_bf16_f32 v84, v68, v69
  v_cvt_pk_bf16_f32 v85, v70, v71
  v_cvt_pk_bf16_f32 v86, v72, v73
  v_cvt_pk_bf16_f32 v87, v74, v75
  v_cvt_pk_bf16_f32 v88, v76, v77
  v_cvt_pk_bf16_f32 v89, v78, v79
  s_cmp_eq_u32 s56, 0
  s_cselect_b64 s[58:59], -1, 0
  v_permlane32_swap_b32 v84, v86
  v_permlane32_swap_b32 v85, v87
  v_cndmask_b32_e64 v88, v89, v88, s[58:59]
  buffer_store_dwordx4 v[84:87], v188, s[20:23], s33 offen sc1
  s_mov_b64 s[58:59], exec
  s_mov_b32 exec_hi, 0
  buffer_store_dword v88, v189, s[20:23], s34 offen sc1
  s_mov_b64 exec, s[58:59]
  s_setprio 0
  s_mov_b32 s36, 7
  s_mul_i32 s32, s36, 4608
  s_add_u32 s32, s32, 119808
  v_add_u32 v10, s32, v240
  v_add_u32 v11, s32, v241
  v_and_b32 v12, s32, v243
  v_add_u32 v12, v242, v12
  v_mov_b32 v14, 0xffffee00
  v_and_b32 v13, v14, v243
  s_sub_u32 s50, 8, s57
  s_call_b64 s[52:53], L_RUNA
  s_branch L_FINALA
L_FINAL0:
  s_waitcnt vmcnt(0)
  s_setprio 0
  s_barrier
  s_nop 7
  s_nop 3
  v_max3_f32 v2, |v68|, |v69|, |v70|
  v_max3_f32 v2, v2, |v71|, |v72|
  v_max3_f32 v2, v2, |v73|, |v74|
  v_max3_f32 v2, v2, |v75|, |v76|
  v_max3_f32 v2, v2, |v77|, |v78|
  v_max_f32_e64 v2, v2, |v79|
  v_mov_b32 v3, 0x21800000
  v_mov_b32 v4, 0x5d800000
  v_mov_b32 v5, 0x7f000000
  v_cmp_nge_f32 vcc, v80, v3
  v_cmp_nle_f32 s[62:63], v80, v4
  s_or_b64 vcc, vcc, s[62:63]
  v_cmp_nlt_f32 s[62:63], v2, v5
  s_or_b64 vcc, vcc, s[62:63]
  s_cmp_eq_u64 vcc, 0
  s_cbranch_scc1 L_SAFEB0
  s_mov_b32 s44, s66
  v_swap_b32 v36, v44
  v_swap_b32 v37, v45
  v_swap_b32 v38, v46
  v_swap_b32 v39, v47
  v_swap_b32 v40, v48
  v_swap_b32 v41, v49
  v_swap_b32 v42, v50
  v_swap_b32 v43, v51
  v_swap_b32 v52, v68
  v_swap_b32 v53, v69
  v_swap_b32 v54, v70
  v_swap_b32 v55, v71
  v_swap_b32 v56, v72
  v_swap_b32 v57, v73
  v_swap_b32 v58, v74
  v_swap_b32 v59, v75
  v_swap_b32 v60, v76
  v_swap_b32 v61, v77
  v_swap_b32 v62, v78
  v_swap_b32 v63, v79
  v_swap_b32 v64, v80
  v_swap_b32 v65, v81
  v_swap_b32 v66, v82
  v_swap_b32 v67, v83
  s_call_b64 s[52:53], L_FB
  v_swap_b32 v36, v44
  v_swap_b32 v37, v45
  v_swap_b32 v38, v46
  v_swap_b32 v39, v47
  v_swap_b32 v40, v48
  v_swap_b32 v41, v49
  v_swap_b32 v42, v50
  v_swap_b32 v43, v51
  v_swap_b32 v52, v68
  v_swap_b32 v53, v69
  v_swap_b32 v54, v70
  v_swap_b32 v55, v71
  v_swap_b32 v56, v72
  v_swap_b32 v57, v73
  v_swap_b32 v58, v74
  v_swap_b32 v59, v75
  v_swap_b32 v60, v76
  v_swap_b32 v61, v77
  v_swap_b32 v62, v78
  v_swap_b32 v63, v79
  v_swap_b32 v64, v80
  v_swap_b32 v65, v81
  v_swap_b32 v66, v82
  v_swap_b32 v67, v83
L_SAFEB0:
  v_rcp_f32 v4, v80
  s_lshl_b32 s32, s66, 15
  s_add_u32 s33, s32, s6
  s_lshl_b32 s32, s66, 7
  s_add_u32 s34, s32, s7
  v_mul_f32 v68, v68, v4
  v_mul_f32 v69, v69, v4
  v_mul_f32 v70, v70, v4
  v_mul_f32 v71, v71, v4
  v_mul_f32 v72, v72, v4
  v_mul_f32 v73, v73, v4
  v_mul_f32 v74, v74, v4
  v_mul_f32 v75, v75, v4
  v_mul_f32 v76, v76, v4
  v_mul_f32 v77, v77, v4
  v_mul_f32 v78, v78, v4
  v_mul_f32 v79, v79, v4
  v_cvt_pk_bf16_f32 v84, v68, v69
  v_cvt_pk_bf16_f32 v85, v70, v71
  v_cvt_pk_bf16_f32 v86, v72, v73
  v_cvt_pk_bf16_f32 v87, v74, v75
  v_cvt_pk_bf16_f32 v88, v76, v77
  v_cvt_pk_bf16_f32 v89, v78, v79
  s_cmp_eq_u32 s56, 0
  s_cselect_b64 s[58:59], -1, 0
  v_permlane32_swap_b32 v84, v86
  v_permlane32_swap_b32 v85, v87
  v_cndmask_b32_e64 v88, v89, v88, s[58:59]
  buffer_store_dwordx4 v[84:87], v188, s[20:23], s33 offen sc1
  s_mov_b64 s[58:59], exec
  s_mov_b32 exec_hi, 0
  buffer_store_dword v88, v189, s[20:23], s34 offen sc1
  s_mov_b64 exec, s[58:59]
L_FINALA:
  s_setprio 0
  s_nop 7
  s_nop 3
  v_max3_f32 v2, |v52|, |v53|, |v54|
  v_max3_f32 v2, v2, |v55|, |v56|
  v_max3_f32 v2, v2, |v57|, |v58|
  v_max3_f32 v2, v2, |v59|, |v60|
  v_max3_f32 v2, v2, |v61|, |v62|
  v_max_f32_e64 v2, v2, |v63|
  v_mov_b32 v3, 0x21800000
  v_mov_b32 v4, 0x5d800000
  v_mov_b32 v5, 0x7f000000
  v_cmp_nge_f32 vcc, v64, v3
  v_cmp_nle_f32 s[62:63], v64, v4
  s_or_b64 vcc, vcc, s[62:63]
  v_cmp_nlt_f32 s[62:63], v2, v5
  s_or_b64 vcc, vcc, s[62:63]
  s_cmp_eq_u64 vcc, 0
  s_cbranch_scc1 L_SAFEA
  s_mov_b32 s44, s57
  s_call_b64 s[52:53], L_FB
L_SAFEA:
  v_rcp_f32 v4, v64
  s_lshl_b32 s32, s57, 15
  s_add_u32 s33, s32, s6
  s_lshl_b32 s32, s57, 7
  s_add_u32 s34, s32, s7
  v_mul_f32 v52, v52, v4
  v_mul_f32 v53, v53, v4
  v_mul_f32 v54, v54, v4
  v_mul_f32 v55, v55, v4
  v_mul_f32 v56, v56, v4
  v_mul_f32 v57, v57, v4
  v_mul_f32 v58, v58, v4
  v_mul_f32 v59, v59, v4
  v_mul_f32 v60, v60, v4
  v_mul_f32 v61, v61, v4
  v_mul_f32 v62, v62, v4
  v_mul_f32 v63, v63, v4
  v_cvt_pk_bf16_f32 v84, v52, v53
  v_cvt_pk_bf16_f32 v85, v54, v55
  v_cvt_pk_bf16_f32 v86, v56, v57
  v_cvt_pk_bf16_f32 v87, v58, v59
  v_cvt_pk_bf16_f32 v88, v60, v61
  v_cvt_pk_bf16_f32 v89, v62, v63
  s_cmp_eq_u32 s56, 0
  s_cselect_b64 s[58:59], -1, 0
  v_permlane32_swap_b32 v84, v86
  v_permlane32_swap_b32 v85, v87
  v_cndmask_b32_e64 v88, v89, v88, s[58:59]
  buffer_store_dwordx4 v[84:87], v188, s[20:23], s33 offen sc1
  s_mov_b64 s[58:59], exec
  s_mov_b32 exec_hi, 0
  buffer_store_dword v88, v189, s[20:23], s34 offen sc1
  s_mov_b64 exec, s[58:59]
  s_branch L_P3
L_FB:
  v_and_b32 v2, 31, v1
  v_lshrrev_b32 v3, 5, v1
  v_lshlrev_b32 v3, 2, v3
  v_sub_u32 v2, v2, v3
  v_mov_b32 v3, 0xff61b1e6
  v_cmp_le_i32 vcc, 0, v2
  s_nop 1
  v_cndmask_b32_e64 v190, v3, 0, vcc
  v_sub_f32 v206, v3, v190
  v_cmp_le_i32 vcc, 1, v2
  s_nop 1
  v_cndmask_b32_e64 v191, v3, 0, vcc
  v_sub_f32 v207, v3, v191
  v_cmp_le_i32 vcc, 2, v2
  s_nop 1
  v_cndmask_b32_e64 v192, v3, 0, vcc
  v_sub_f32 v208, v3, v192
  v_cmp_le_i32 vcc, 3, v2
  s_nop 1
  v_cndmask_b32_e64 v193, v3, 0, vcc
  v_sub_f32 v209, v3, v193
  v_cmp_le_i32 vcc, 8, v2
  s_nop 1
  v_cndmask_b32_e64 v194, v3, 0, vcc
  v_sub_f32 v210, v3, v194
  v_cmp_le_i32 vcc, 9, v2
  s_nop 1
  v_cndmask_b32_e64 v195, v3, 0, vcc
  v_sub_f32 v211, v3, v195
  v_cmp_le_i32 vcc, 10, v2
  s_nop 1
  v_cndmask_b32_e64 v196, v3, 0, vcc
  v_sub_f32 v212, v3, v196
  v_cmp_le_i32 vcc, 11, v2
  s_nop 1
  v_cndmask_b32_e64 v197, v3, 0, vcc
  v_sub_f32 v213, v3, v197
  v_cmp_le_i32 vcc, 16, v2
  s_nop 1
  v_cndmask_b32_e64 v198, v3, 0, vcc
  v_sub_f32 v214, v3, v198
  v_cmp_le_i32 vcc, 17, v2
  s_nop 1
  v_cndmask_b32_e64 v199, v3, 0, vcc
  v_sub_f32 v215, v3, v199
  v_cmp_le_i32 vcc, 18, v2
  s_nop 1
  v_cndmask_b32_e64 v200, v3, 0, vcc
  v_sub_f32 v216, v3, v200
  v_cmp_le_i32 vcc, 19, v2
  s_nop 1
  v_cndmask_b32_e64 v201, v3, 0, vcc
  v_sub_f32 v217, v3, v201
  v_cmp_le_i32 vcc, 24, v2
  s_nop 1
  v_cndmask_b32_e64 v202, v3, 0, vcc
  v_sub_f32 v218, v3, v202
  v_cmp_le_i32 vcc, 25, v2
  s_nop 1
  v_cndmask_b32_e64 v203, v3, 0, vcc
  v_sub_f32 v219, v3, v203
  v_cmp_le_i32 vcc, 26, v2
  s_nop 1
  v_cndmask_b32_e64 v204, v3, 0, vcc
  v_sub_f32 v220, v3, v204
  v_cmp_le_i32 vcc, 27, v2
  s_nop 1
  v_cndmask_b32_e64 v205, v3, 0, vcc
  v_sub_f32 v221, v3, v205
  v_mov_b32 v222, 0xff800000
  s_mov_b32 s47, 0
L_FB_PASS:
  s_mov_b32 s48, 0
L_FB_OWN:
  s_mul_i32 s45, s48, 4608
  s_add_u32 s45, s45, 82944
  s_cmp_eq_u32 s48, s44
  s_cselect_b32 s46, 1, 0
  s_call_b64 s[64:65], L_FB_TILE
  s_add_u32 s48, s48, 1
  s_cmp_le_u32 s48, s44
  s_cbranch_scc1 L_FB_OWN
  s_cmp_eq_u32 s29, 0
  s_cbranch_scc1 L_FB_PEND
  s_mov_b32 s48, s44
L_FB_HALO:
  s_mul_i32 s45, s48, 4608
  s_add_u32 s45, s45, 119808
  s_cmp_eq_u32 s48, s44
  s_cselect_b32 s46, 2, 0
  s_call_b64 s[64:65], L_FB_TILE
  s_add_u32 s48, s48, 1
  s_cmp_le_u32 s48, 7
  s_cbranch_scc1 L_FB_HALO
L_FB_PEND:
  s_cmp_eq_u32 s47, 1
  s_cbranch_scc1 L_FB_DONE
  v_mov_b32 v2, v222
  s_nop 1
  v_permlane32_swap_b32 v222, v2
  s_nop 1
  v_max_f32 v222, v222, v2
  v_mov_b32 v52, 0
  v_mov_b32 v53, 0
  v_mov_b32 v54, 0
  v_mov_b32 v55, 0
  v_mov_b32 v56, 0
  v_mov_b32 v57, 0
  v_mov_b32 v58, 0
  v_mov_b32 v59, 0
  v_mov_b32 v60, 0
  v_mov_b32 v61, 0
  v_mov_b32 v62, 0
  v_mov_b32 v63, 0
  v_mov_b32 v64, 0
  v_mov_b32 v65, 0
  v_mov_b32 v66, 0
  v_mov_b32 v67, 0
  s_mov_b32 s47, 1
  s_branch L_FB_PASS
L_FB_DONE:
  s_nop 15
  s_setpc_b64 s[52:53]
L_FB_TILE:
  v_add_u32 v10, s45, v240
  v_add_u32 v11, s45, v241
  v_and_b32 v12, s45, v243
  v_add_u32 v12, v242, v12
  ds_read_b128 v[124:127], v10
  ds_read_b64 v[128:129], v11
  ds_read_b64_tr_b16 v[132:133], v12
  ds_read_b64_tr_b16 v[134:135], v12 offset:576
  ds_read_b64_tr_b16 v[136:137], v12 offset:1152
  ds_read_b64_tr_b16 v[138:139], v12 offset:1728
  s_waitcnt lgkmcnt(0)
  v_mfma_f32_32x32x16_bf16 v[84:99], v[124:127], v[36:39], 0
  v_mfma_f32_32x32x16_bf16 v[84:99], v[128:131], v[40:43], v[84:99]
  s_nop 15
  s_cmp_eq_u32 s46, 0
  s_cbranch_scc1 L_FB_NM
  s_cmp_eq_u32 s46, 1
  s_cbranch_scc0 L_FB_FM
  v_add_f32 v84, v84, v190
  v_add_f32 v85, v85, v191
  v_add_f32 v86, v86, v192
  v_add_f32 v87, v87, v193
  v_add_f32 v88, v88, v194
  v_add_f32 v89, v89, v195
  v_add_f32 v90, v90, v196
  v_add_f32 v91, v91, v197
  v_add_f32 v92, v92, v198
  v_add_f32 v93, v93, v199
  v_add_f32 v94, v94, v200
  v_add_f32 v95, v95, v201
  v_add_f32 v96, v96, v202
  v_add_f32 v97, v97, v203
  v_add_f32 v98, v98, v204
  v_add_f32 v99, v99, v205
  s_branch L_FB_NM
L_FB_FM:
  v_add_f32 v84, v84, v206
  v_add_f32 v85, v85, v207
  v_add_f32 v86, v86, v208
  v_add_f32 v87, v87, v209
  v_add_f32 v88, v88, v210
  v_add_f32 v89, v89, v211
  v_add_f32 v90, v90, v212
  v_add_f32 v91, v91, v213
  v_add_f32 v92, v92, v214
  v_add_f32 v93, v93, v215
  v_add_f32 v94, v94, v216
  v_add_f32 v95, v95, v217
  v_add_f32 v96, v96, v218
  v_add_f32 v97, v97, v219
  v_add_f32 v98, v98, v220
  v_add_f32 v99, v99, v221
L_FB_NM:
  s_cmp_eq_u32 s47, 0
  s_cbranch_scc0 L_FB_P1
  v_max3_f32 v222, v222, v84, v85
  v_max3_f32 v222, v222, v86, v87
  v_max3_f32 v222, v222, v88, v89
  v_max3_f32 v222, v222, v90, v91
  v_max3_f32 v222, v222, v92, v93
  v_max3_f32 v222, v222, v94, v95
  v_max3_f32 v222, v222, v96, v97
  v_max3_f32 v222, v222, v98, v99
  s_setpc_b64 s[64:65]
L_FB_P1:
  v_sub_f32 v84, v84, v222
  v_sub_f32 v85, v85, v222
  v_sub_f32 v86, v86, v222
  v_sub_f32 v87, v87, v222
  v_sub_f32 v88, v88, v222
  v_sub_f32 v89, v89, v222
  v_sub_f32 v90, v90, v222
  v_sub_f32 v91, v91, v222
  v_sub_f32 v92, v92, v222
  v_sub_f32 v93, v93, v222
  v_sub_f32 v94, v94, v222
  v_sub_f32 v95, v95, v222
  v_sub_f32 v96, v96, v222
  v_sub_f32 v97, v97, v222
  v_sub_f32 v98, v98, v222
  v_sub_f32 v99, v99, v222
  v_exp_f32 v100, v84
  v_exp_f32 v101, v85
  v_exp_f32 v102, v86
  v_exp_f32 v103, v87
  v_exp_f32 v104, v88
  v_exp_f32 v105, v89
  v_exp_f32 v106, v90
  v_exp_f32 v107, v91
  v_exp_f32 v108, v92
  v_exp_f32 v109, v93
  v_exp_f32 v110, v94
  v_exp_f32 v111, v95
  v_exp_f32 v112, v96
  v_exp_f32 v113, v97
  v_exp_f32 v114, v98
  v_exp_f32 v115, v99
  s_nop 0
  v_cvt_pk_bf16_f32 v116, v100, v101
  v_cvt_pk_bf16_f32 v117, v102, v103
  v_cvt_pk_bf16_f32 v118, v104, v105
  v_cvt_pk_bf16_f32 v119, v106, v107
  v_cvt_pk_bf16_f32 v120, v108, v109
  v_cvt_pk_bf16_f32 v121, v110, v111
  v_cvt_pk_bf16_f32 v122, v112, v113
  v_cvt_pk_bf16_f32 v123, v114, v115
  s_nop 1
  v_mfma_f32_32x32x16_bf16 v[52:67], v[132:135], v[116:119], v[52:67]
  v_mfma_f32_32x32x16_bf16 v[52:67], v[136:139], v[120:123], v[52:67]
  s_nop 7
  s_setpc_b64 s[64:65]
L_HOOK:
  s_cmp_eq_u32 s67, 1
  s_cbranch_scc1 L_HK1
  s_cmp_eq_u32 s67, 2
  s_cbranch_scc1 L_HK2
  s_cmp_eq_u32 s67, 3
  s_cbranch_scc1 L_HK3
  s_cmp_eq_u32 s67, 5
  s_cbranch_scc0 L_HK0
  s_mov_b32 s67, 3
  s_mov_b32 s61, 15
  s_waitcnt vmcnt(0)
  v_mov_b32 v2, 158744
  v_mov_b32 v3, 1
  s_mov_b64 s[58:59], exec
  s_mov_b64 exec, 1
  ds_add_rtn_u32 v4, v2, v3
  s_mov_b64 exec, s[58:59]
  s_waitcnt lgkmcnt(0)
  v_readfirstlane_b32 s32, v4
  s_cmp_lg_u32 s32, 3
  s_cbranch_scc1 L_CLR
  s_lshl_b32 s32, s30, 2
  s_add_u32 s32, s32, s5
  v_lshlrev_b32 v2, 7, v1
  v_mov_b32 v3, s42
  s_mov_b64 s[58:59], exec
  s_mov_b64 exec, 0xffff
  buffer_store_dword v3, v2, s[20:23], s32 offen offset:128 sc1
  s_mov_b64 exec, s[58:59]
L_CLR:
  s_branch L_HRET
L_HK0:
  s_mov_b32 s67, 1
  s_mov_b32 s61, 6
  s_cmp_eq_u32 s29, 7
  s_cbranch_scc1 L_HRET
  s_waitcnt vmcnt(0)
  s_lshl_b32 s32, s54, 8
  s_lshl_b32 s33, s39, 2
  s_add_u32 s32, s32, s33
  s_add_u32 s32, s32, 14155904
  v_mov_b32 v2, 0
  v_mov_b32 v3, s41
  s_mov_b64 s[58:59], exec
  s_mov_b64 exec, 1
  buffer_store_dword v3, v2, s[20:23], s32 offen sc1
  s_mov_b64 exec, s[58:59]
  s_branch L_HRET
L_HK3:
  s_mov_b32 s67, 4
  s_mov_b32 s61, 1000
  s_lshl_b32 s32, s30, 7
  s_add_u32 s32, s32, s5
  s_mov_b64 s[58:59], exec
  s_mov_b64 exec, 0xffff
  v_lshlrev_b32 v2, 2, v1
  buffer_load_dword v237, v2, s[20:23], s32 offen offset:128 sc1
  s_mov_b64 exec, s[58:59]
  s_branch L_HRET
L_HK1:
  s_mov_b32 s67, 2
  s_mov_b32 s61, 8
  s_cmp_eq_u32 s29, 0
  s_cbranch_scc0 L_HK1A
  s_mov_b32 s61, 1000
  s_branch L_HRET
L_HK1A:
  s_sub_u32 s69, s54, 1
  s_lshl_b32 s69, s69, 8
  s_lshl_b32 s32, s39, 2
  s_add_u32 s69, s69, s32
  s_add_u32 s69, s69, 14155904
  v_mov_b32 v2, 0
  buffer_load_dword v236, v2, s[20:23], s69 offen sc1
  s_branch L_HRET
L_HK2:
  s_mov_b32 s67, 3
  s_mov_b32 s61, 15
  s_waitcnt vmcnt(0)
  v_readfirstlane_b32 s32, v236
  s_cmp_eq_u32 s32, s40
  s_cbranch_scc1 L_POLL1_OK
  v_mov_b32 v2, 0
  s_mov_b32 s60, 0
L_POLL1:
  buffer_load_dword v236, v2, s[20:23], s69 offen sc1
L_POLL1_W:
  s_add_u32 s60, s60, 1
  s_waitcnt vmcnt(0)
  v_readfirstlane_b32 s32, v236
  s_cmp_eq_u32 s32, s40
  s_cbranch_scc1 L_POLL1_OK
  s_cmp_lt_u32 s60, 2000000
  s_cbranch_scc1 L_POLL1
L_POLL1_OK:
  s_sub_u32 s32, s54, 1
  s_mul_i32 s32, s32, 36864
  s_add_u32 s33, s32, 32768
  buffer_load_dwordx4 v[140:143], v184, s[20:23], s33 offen sc1
  s_add_u32 s33, s32, 28672
  buffer_load_dwordx4 v[144:147], v184, s[20:23], s33 offen sc1
  s_add_u32 s33, s32, 24576
  buffer_load_dwordx4 v[148:151], v184, s[20:23], s33 offen sc1
  s_add_u32 s33, s32, 20480
  buffer_load_dwordx4 v[152:155], v184, s[20:23], s33 offen sc1
  s_add_u32 s33, s32, 16384
  buffer_load_dwordx4 v[156:159], v184, s[20:23], s33 offen sc1
  s_add_u32 s33, s32, 12288
  buffer_load_dwordx4 v[160:163], v184, s[20:23], s33 offen sc1
  s_add_u32 s33, s32, 8192
  buffer_load_dwordx4 v[164:167], v184, s[20:23], s33 offen sc1
  s_add_u32 s33, s32, 4096
  buffer_load_dwordx4 v[168:171], v184, s[20:23], s33 offen sc1
  s_add_u32 s33, s32, 0
  buffer_load_dwordx4 v[172:175], v184, s[20:23], s33 offen sc1
L_HRET:
  s_setpc_b64 s[64:65]
L_RUNA:
  ds_read_b128 v[124:127], v10
  ds_read_b64 v[128:129], v11
  s_cmp_eq_u32 s50, 1
  s_cbranch_scc1 L_RUNA_M1
  v_add_u32 v10, v14, v10
  v_add_u32 v11, v14, v11
  s_waitcnt lgkmcnt(0)
  v_mfma_f32_32x32x16_bf16 v[84:99], v[124:127], v[36:39], 0
  v_mfma_f32_32x32x16_bf16 v[84:99], v[128:131], v[40:43], v[84:99]
  ds_read_b64_tr_b16 v[132:133], v12 offset:0
  ds_read_b64_tr_b16 v[134:135], v12 offset:576
  ds_read_b128 v[124:127], v10
  ds_read_b64 v[128:129], v11
  ds_read_b64_tr_b16 v[136:137], v12 offset:1152
  ds_read_b64_tr_b16 v[138:139], v12 offset:1728
  v_add_u32 v12, v13, v12
  s_sub_u32 s50, s50, 2
L_RUNA_BT:
  s_cmp_eq_u32 s50, 0
  s_cbranch_scc1 L_RUNA_MK0
  s_sub_u32 s98, s61, s51
  s_min_u32 s98, s98, s50
  s_sub_u32 s50, s50, s98
  s_add_u32 s51, s51, s98
  s_sub_u32 s98, s98, 1
L_RUNA_LP:
  v_exp_f32 v100, v84
  v_exp_f32 v101, v85
  v_exp_f32 v102, v86
  v_exp_f32 v103, v87
  v_exp_f32 v104, v88
  v_exp_f32 v105, v89
  v_exp_f32 v106, v90
  v_exp_f32 v107, v91
  v_cvt_pk_bf16_f32 v116, v100, v101
  v_cvt_pk_bf16_f32 v117, v102, v103
  v_cvt_pk_bf16_f32 v118, v104, v105
  v_cvt_pk_bf16_f32 v119, v106, v107
  v_exp_f32 v108, v92
  v_exp_f32 v109, v93
  s_waitcnt lgkmcnt(0)
  v_mfma_f32_32x32x16_bf16 v[52:67], v[132:135], v[116:119], v[52:67]
  v_exp_f32 v110, v94
  v_exp_f32 v111, v95
  v_exp_f32 v112, v96
  v_exp_f32 v113, v97
  v_exp_f32 v114, v98
  v_exp_f32 v115, v99
  v_mfma_f32_32x32x16_bf16 v[84:99], v[124:127], v[36:39], 0
  v_cvt_pk_bf16_f32 v120, v108, v109
  v_cvt_pk_bf16_f32 v121, v110, v111
  v_cvt_pk_bf16_f32 v122, v112, v113
  v_cvt_pk_bf16_f32 v123, v114, v115
  ds_read_b64_tr_b16 v[132:133], v12 offset:0
  ds_read_b64_tr_b16 v[134:135], v12 offset:576
  v_mfma_f32_32x32x16_bf16 v[84:99], v[128:131], v[40:43], v[84:99]
  v_add_u32 v10, v14, v10
  v_add_u32 v11, v14, v11
  ds_read_b128 v[124:127], v10
  ds_read_b64 v[128:129], v11
  v_mfma_f32_32x32x16_bf16 v[52:67], v[136:139], v[120:123], v[52:67]
  ds_read_b64_tr_b16 v[136:137], v12 offset:1152
  ds_read_b64_tr_b16 v[138:139], v12 offset:1728
  v_add_u32 v12, v13, v12
  s_sub_u32 s98, s98, 1
  s_nop 1
  s_cbranch_scc0 L_RUNA_LP
  s_cmp_lg_u32 s51, s61
  s_cbranch_scc1 L_RUNA_BT
  s_call_b64 s[64:65], L_HOOK
  s_branch L_RUNA_BT
L_RUNA_MK0:
  s_nop 3
L_RUNA_MK:
  v_exp_f32 v100, v84
  v_exp_f32 v101, v85
  v_exp_f32 v102, v86
  v_exp_f32 v103, v87
  v_exp_f32 v104, v88
  v_exp_f32 v105, v89
  v_exp_f32 v106, v90
  v_exp_f32 v107, v91
  v_cvt_pk_bf16_f32 v116, v100, v101
  v_cvt_pk_bf16_f32 v117, v102, v103
  v_cvt_pk_bf16_f32 v118, v104, v105
  v_cvt_pk_bf16_f32 v119, v106, v107
  v_exp_f32 v108, v92
  v_exp_f32 v109, v93
  s_waitcnt lgkmcnt(0)
  v_mfma_f32_32x32x16_bf16 v[52:67], v[132:135], v[116:119], v[52:67]
  v_exp_f32 v110, v94
  v_exp_f32 v111, v95
  v_exp_f32 v112, v96
  v_exp_f32 v113, v97
  v_exp_f32 v114, v98
  v_exp_f32 v115, v99
  v_mfma_f32_32x32x16_bf16 v[84:99], v[124:127], v[36:39], v[20:35]
  v_cvt_pk_bf16_f32 v120, v108, v109
  v_cvt_pk_bf16_f32 v121, v110, v111
  v_cvt_pk_bf16_f32 v122, v112, v113
  v_cvt_pk_bf16_f32 v123, v114, v115
  ds_read_b64_tr_b16 v[132:133], v12 offset:0
  ds_read_b64_tr_b16 v[134:135], v12 offset:576
  v_mfma_f32_32x32x16_bf16 v[84:99], v[128:131], v[40:43], v[84:99]
  v_add_u32 v10, v14, v10
  v_add_u32 v11, v14, v11
  ds_read_b128 v[124:127], v10
  ds_read_b64 v[128:129], v11
  v_mfma_f32_32x32x16_bf16 v[52:67], v[136:139], v[120:123], v[52:67]
  ds_read_b64_tr_b16 v[136:137], v12 offset:1152
  ds_read_b64_tr_b16 v[138:139], v12 offset:1728
  v_add_u32 v12, v13, v12
  s_add_u32 s51, s51, 1
  s_cmp_lg_u32 s51, s61
  s_cbranch_scc1 L_RUNA_H1
  s_call_b64 s[64:65], L_HOOK
L_RUNA_H1:
  s_nop 1
L_RUNA_FN:
  v_exp_f32 v100, v84
  v_exp_f32 v101, v85
  v_exp_f32 v102, v86
  v_exp_f32 v103, v87
  v_exp_f32 v104, v88
  v_exp_f32 v105, v89
  v_exp_f32 v106, v90
  v_exp_f32 v107, v91
  v_cvt_pk_bf16_f32 v116, v100, v101
  v_cvt_pk_bf16_f32 v117, v102, v103
  v_cvt_pk_bf16_f32 v118, v104, v105
  v_cvt_pk_bf16_f32 v119, v106, v107
  v_exp_f32 v108, v92
  v_exp_f32 v109, v93
  s_waitcnt lgkmcnt(0)
  v_mfma_f32_32x32x16_bf16 v[52:67], v[132:135], v[116:119], v[52:67]
  v_exp_f32 v110, v94
  v_exp_f32 v111, v95
  v_exp_f32 v112, v96
  v_exp_f32 v113, v97
  v_exp_f32 v114, v98
  v_exp_f32 v115, v99
  s_nop 0
  v_cvt_pk_bf16_f32 v120, v108, v109
  v_cvt_pk_bf16_f32 v121, v110, v111
  v_cvt_pk_bf16_f32 v122, v112, v113
  v_cvt_pk_bf16_f32 v123, v114, v115
  s_nop 1
  v_mfma_f32_32x32x16_bf16 v[52:67], v[136:139], v[120:123], v[52:67]
  s_add_u32 s51, s51, 1
  s_cmp_lg_u32 s51, s61
  s_cbranch_scc1 L_RUNA_H2
  s_call_b64 s[64:65], L_HOOK
L_RUNA_H2:
  s_setpc_b64 s[52:53]
L_RUNA_M1:
  s_waitcnt lgkmcnt(0)
  v_mfma_f32_32x32x16_bf16 v[84:99], v[124:127], v[36:39], v[20:35]
  v_mfma_f32_32x32x16_bf16 v[84:99], v[128:131], v[40:43], v[84:99]
  ds_read_b64_tr_b16 v[132:133], v12 offset:0
  ds_read_b64_tr_b16 v[134:135], v12 offset:576
  ds_read_b64_tr_b16 v[136:137], v12 offset:1152
  ds_read_b64_tr_b16 v[138:139], v12 offset:1728
  s_nop 7
  s_branch L_RUNA_FN
L_RUNB:
  ds_read_b128 v[124:127], v10
  ds_read_b64 v[128:129], v11
  s_cmp_eq_u32 s50, 1
  s_cbranch_scc1 L_RUNB_M1
  v_add_u32 v10, v14, v10
  v_add_u32 v11, v14, v11
  s_waitcnt lgkmcnt(0)
  v_mfma_f32_32x32x16_bf16 v[84:99], v[124:127], v[44:47], 0
  v_mfma_f32_32x32x16_bf16 v[84:99], v[128:131], v[48:51], v[84:99]
  ds_read_b64_tr_b16 v[132:133], v12 offset:0
  ds_read_b64_tr_b16 v[134:135], v12 offset:576
  ds_read_b128 v[124:127], v10
  ds_read_b64 v[128:129], v11
  ds_read_b64_tr_b16 v[136:137], v12 offset:1152
  ds_read_b64_tr_b16 v[138:139], v12 offset:1728
  v_add_u32 v12, v13, v12
  s_sub_u32 s50, s50, 2
L_RUNB_BT:
  s_cmp_eq_u32 s50, 0
  s_cbranch_scc1 L_RUNB_MK0
  s_sub_u32 s98, s61, s51
  s_min_u32 s98, s98, s50
  s_sub_u32 s50, s50, s98
  s_add_u32 s51, s51, s98
  s_sub_u32 s98, s98, 1
L_RUNB_LP:
  v_exp_f32 v100, v84
  v_exp_f32 v101, v85
  v_exp_f32 v102, v86
  v_exp_f32 v103, v87
  v_exp_f32 v104, v88
  v_exp_f32 v105, v89
  v_exp_f32 v106, v90
  v_exp_f32 v107, v91
  v_cvt_pk_bf16_f32 v116, v100, v101
  v_cvt_pk_bf16_f32 v117, v102, v103
  v_cvt_pk_bf16_f32 v118, v104, v105
  v_cvt_pk_bf16_f32 v119, v106, v107
  v_exp_f32 v108, v92
  v_exp_f32 v109, v93
  s_waitcnt lgkmcnt(0)
  v_mfma_f32_32x32x16_bf16 v[68:83], v[132:135], v[116:119], v[68:83]
  v_exp_f32 v110, v94
  v_exp_f32 v111, v95
  v_exp_f32 v112, v96
  v_exp_f32 v113, v97
  v_exp_f32 v114, v98
  v_exp_f32 v115, v99
  v_mfma_f32_32x32x16_bf16 v[84:99], v[124:127], v[44:47], 0
  v_cvt_pk_bf16_f32 v120, v108, v109
  v_cvt_pk_bf16_f32 v121, v110, v111
  v_cvt_pk_bf16_f32 v122, v112, v113
  v_cvt_pk_bf16_f32 v123, v114, v115
  ds_read_b64_tr_b16 v[132:133], v12 offset:0
  ds_read_b64_tr_b16 v[134:135], v12 offset:576
  v_mfma_f32_32x32x16_bf16 v[84:99], v[128:131], v[48:51], v[84:99]
  v_add_u32 v10, v14, v10
  v_add_u32 v11, v14, v11
  ds_read_b128 v[124:127], v10
  ds_read_b64 v[128:129], v11
  v_mfma_f32_32x32x16_bf16 v[68:83], v[136:139], v[120:123], v[68:83]
  ds_read_b64_tr_b16 v[136:137], v12 offset:1152
  ds_read_b64_tr_b16 v[138:139], v12 offset:1728
  v_add_u32 v12, v13, v12
  s_sub_u32 s98, s98, 1
  s_nop 1
  s_cbranch_scc0 L_RUNB_LP
  s_cmp_lg_u32 s51, s61
  s_cbranch_scc1 L_RUNB_BT
  s_call_b64 s[64:65], L_HOOK
  s_branch L_RUNB_BT
L_RUNB_MK0:
  s_nop 3
L_RUNB_MK:
  v_exp_f32 v100, v84
  v_exp_f32 v101, v85
  v_exp_f32 v102, v86
  v_exp_f32 v103, v87
  v_exp_f32 v104, v88
  v_exp_f32 v105, v89
  v_exp_f32 v106, v90
  v_exp_f32 v107, v91
  v_cvt_pk_bf16_f32 v116, v100, v101
  v_cvt_pk_bf16_f32 v117, v102, v103
  v_cvt_pk_bf16_f32 v118, v104, v105
  v_cvt_pk_bf16_f32 v119, v106, v107
  v_exp_f32 v108, v92
  v_exp_f32 v109, v93
  s_waitcnt lgkmcnt(0)
  v_mfma_f32_32x32x16_bf16 v[68:83], v[132:135], v[116:119], v[68:83]
  v_exp_f32 v110, v94
  v_exp_f32 v111, v95
  v_exp_f32 v112, v96
  v_exp_f32 v113, v97
  v_exp_f32 v114, v98
  v_exp_f32 v115, v99
  v_mfma_f32_32x32x16_bf16 v[84:99], v[124:127], v[44:47], v[20:35]
  v_cvt_pk_bf16_f32 v120, v108, v109
  v_cvt_pk_bf16_f32 v121, v110, v111
  v_cvt_pk_bf16_f32 v122, v112, v113
  v_cvt_pk_bf16_f32 v123, v114, v115
  ds_read_b64_tr_b16 v[132:133], v12 offset:0
  ds_read_b64_tr_b16 v[134:135], v12 offset:576
  v_mfma_f32_32x32x16_bf16 v[84:99], v[128:131], v[48:51], v[84:99]
  v_add_u32 v10, v14, v10
  v_add_u32 v11, v14, v11
  ds_read_b128 v[124:127], v10
  ds_read_b64 v[128:129], v11
  v_mfma_f32_32x32x16_bf16 v[68:83], v[136:139], v[120:123], v[68:83]
  ds_read_b64_tr_b16 v[136:137], v12 offset:1152
  ds_read_b64_tr_b16 v[138:139], v12 offset:1728
  v_add_u32 v12, v13, v12
  s_add_u32 s51, s51, 1
  s_cmp_lg_u32 s51, s61
  s_cbranch_scc1 L_RUNB_H1
  s_call_b64 s[64:65], L_HOOK
L_RUNB_H1:
  s_nop 1
L_RUNB_FN:
  v_exp_f32 v100, v84
  v_exp_f32 v101, v85
  v_exp_f32 v102, v86
  v_exp_f32 v103, v87
  v_exp_f32 v104, v88
  v_exp_f32 v105, v89
  v_exp_f32 v106, v90
  v_exp_f32 v107, v91
  v_cvt_pk_bf16_f32 v116, v100, v101
  v_cvt_pk_bf16_f32 v117, v102, v103
  v_cvt_pk_bf16_f32 v118, v104, v105
  v_cvt_pk_bf16_f32 v119, v106, v107
  v_exp_f32 v108, v92
  v_exp_f32 v109, v93
  s_waitcnt lgkmcnt(0)
  v_mfma_f32_32x32x16_bf16 v[68:83], v[132:135], v[116:119], v[68:83]
  v_exp_f32 v110, v94
  v_exp_f32 v111, v95
  v_exp_f32 v112, v96
  v_exp_f32 v113, v97
  v_exp_f32 v114, v98
  v_exp_f32 v115, v99
  s_nop 0
  v_cvt_pk_bf16_f32 v120, v108, v109
  v_cvt_pk_bf16_f32 v121, v110, v111
  v_cvt_pk_bf16_f32 v122, v112, v113
  v_cvt_pk_bf16_f32 v123, v114, v115
  s_nop 1
  v_mfma_f32_32x32x16_bf16 v[68:83], v[136:139], v[120:123], v[68:83]
  s_add_u32 s51, s51, 1
  s_cmp_lg_u32 s51, s61
  s_cbranch_scc1 L_RUNB_H2
  s_call_b64 s[64:65], L_HOOK
L_RUNB_H2:
  s_setpc_b64 s[52:53]
L_RUNB_M1:
  s_waitcnt lgkmcnt(0)
  v_mfma_f32_32x32x16_bf16 v[84:99], v[124:127], v[44:47], v[20:35]
  v_mfma_f32_32x32x16_bf16 v[84:99], v[128:131], v[48:51], v[84:99]
  ds_read_b64_tr_b16 v[132:133], v12 offset:0
  ds_read_b64_tr_b16 v[134:135], v12 offset:576
  ds_read_b64_tr_b16 v[136:137], v12 offset:1152
  ds_read_b64_tr_b16 v[138:139], v12 offset:1728
  s_nop 7
  s_branch L_RUNB_FN
L_P3:
  s_lshl_b32 s4, s30, 7
  s_add_u32 s4, s4, s5
  s_lshr_b32 s33, s30, 3
  s_lshl_b32 s33, s33, 3
  s_lshl_b32 s34, s57, 1
  s_add_u32 s33, s33, s34
  s_lshl_b32 s32, s55, 18
  s_add_u32 s32, s32, 9437184
  s_lshl_b32 s34, s33, 14
  s_add_u32 s40, s32, s34
  s_lshl_b32 s32, s55, 15
  s_add_u32 s32, s32, 13631488
  s_lshl_b32 s34, s33, 6
  s_add_u32 s68, s32, s34
  v_lshrrev_b32 v16, 4, v1
  v_lshlrev_b32 v16, 12, v16
  v_and_b32 v6, 15, v1
  v_lshl_add_u32 v16, v6, 2, v16
  v_add_u32 v17, 64, v16
  v_lshrrev_b32 v3, 4, v1
  v_bfe_u32 v4, v1, 2, 2
  v_and_b32 v5, 3, v1
  v_lshrrev_b32 v6, 1, v3
  v_lshlrev_b32 v6, 2, v6
  v_lshl_add_u32 v6, v3, 3, v6
  v_add_u32 v6, v6, v4
  v_mul_u32_u24 v6, 144, v6
  v_lshl_add_u32 v10, v5, 3, v6
  s_mul_i32 s32, s56, 46656
  v_add_u32 v10, s32, v10
  v_mul_u32_u24 v6, 72, v3
  v_add3_u32 v6, v6, v4, 16
  v_mul_u32_u24 v6, 144, v6
  v_lshl_add_u32 v11, v5, 3, v6
  v_lshlrev_b32 v14, 4, v1
  s_lshl_b32 s33, s33, 4
  s_lshl_b32 s34, s29, 8
  s_add_u32 s33, s33, s34
  s_lshl_b32 s34, s56, 4
  s_add_u32 s33, s33, s34
  s_mul_i32 s33, s33, 2304
  s_mul_i32 s34, s28, 1152
  s_add_u32 s33, s33, s34
  s_and_b32 s34, s30, 7
  s_mul_i32 s34, s34, 144
  s_add_u32 s37, s33, s34
  v_and_b32 v15, 15, v1
  v_mul_u32_u24 v15, 2304, v15
  v_lshrrev_b32 v6, 4, v1
  v_lshl_add_u32 v15, v6, 3, v15
  s_mul_i32 s32, s31, 5120
  s_add_u32 s32, s32, 82944
  v_add_u32 v18, s32, v14
  s_xor_b32 s33, s31, 4
  s_mul_i32 s33, s33, 5120
  s_add_u32 s33, s33, 82944
  v_add_u32 v19, s33, v14
  v_mov_b32 v2, 158748
  v_mov_b32 v3, 1
  s_mov_b64 s[58:59], exec
  s_mov_b64 exec, 1
  ds_add_u32 v2, v3
  s_mov_b64 exec, s[58:59]
  s_cmp_eq_u32 s67, 4
  s_cbranch_scc0 L_P3C0
  s_waitcnt vmcnt(2)
  v_mov_b32 v13, v237
  s_branch L_P3C1
L_P3C0:
  s_mov_b64 s[58:59], exec
  s_mov_b64 exec, 0xffff
  v_lshlrev_b32 v4, 2, v1
  buffer_load_dword v13, v4, s[20:23], s4 offen offset:128 sc1
  s_mov_b64 exec, s[58:59]
  s_waitcnt vmcnt(0)
L_P3C1:
  s_mov_b64 s[58:59], exec
  s_mov_b64 exec, 0xffff
  v_cmp_ne_u32 vcc, s42, v13
  s_nop 1
  s_cmp_eq_u64 vcc, 0
  s_cbranch_scc1 L_POLLC_OK
  v_lshlrev_b32 v4, 2, v1
  s_mov_b32 s60, 0
L_POLLC:
  buffer_load_dword v13, v4, s[20:23], s4 offen offset:128 sc1
L_POLLC_W:
  s_add_u32 s60, s60, 1
  s_waitcnt vmcnt(0)
  v_cmp_ne_u32 vcc, s42, v13
  s_nop 1
  s_cmp_eq_u64 vcc, 0
  s_cbranch_scc1 L_POLLC_OK
  s_cmp_lt_u32 s60, 2000000
  s_cbranch_scc1 L_POLLC
L_POLLC_OK:
  s_mov_b64 exec, s[58:59]
  s_cmp_eq_u32 s56, 0
  s_cbranch_scc0 L_P3K1
  ds_read_b64_tr_b16 v[132:133], v10 offset:0
  ds_read_b64_tr_b16 v[134:135], v10 offset:576
  ds_read_b64_tr_b16 v[136:137], v10 offset:32
  ds_read_b64_tr_b16 v[138:139], v10 offset:608
  ds_read_b64_tr_b16 v[140:141], v10 offset:64
  ds_read_b64_tr_b16 v[142:143], v10 offset:640
  ds_read_b64_tr_b16 v[144:145], v10 offset:96
  ds_read_b64_tr_b16 v[146:147], v10 offset:672
  ds_read_b64_tr_b16 v[148:149], v10 offset:128
  ds_read_b64_tr_b16 v[150:151], v10 offset:704
  s_lshr_b32 s32, 0x55AA, s30
  s_bitcmp1_b32 s32, 0
  s_cbranch_scc1 L_SGK0_GO
  v_mov_b32 v5, 17404
  v_lshlrev_b32 v12, 11, v1
  v_add_u32 v12, v5, v12
  s_mov_b64 s[58:59], exec
  s_mov_b64 exec, 0xf
  s_mov_b32 s60, 0
L_SGK0_P:
  buffer_load_dword v9, v12, s[20:23], s40 offen sc1
L_SGK0_PW:
  s_add_u32 s60, s60, 1
  s_waitcnt vmcnt(0)
  v_cmp_eq_u32 vcc, -1, v9
  s_nop 1
  s_cmp_eq_u64 vcc, 0
  s_cbranch_scc1 L_SGK0_PO
  s_cmp_lt_u32 s60, 2000000
  s_cbranch_scc1 L_SGK0_P
L_SGK0_PO:
  s_mov_b64 exec, s[58:59]
L_SGK0_GO:
  s_mov_b32 s50, 0
L_SGVK0_L:
  s_add_u32 s32, s40, 0
  s_add_u32 s33, s40, 16384
  buffer_load_dwordx4 v[20:23], v14, s[20:23], s32 offen sc1
  buffer_load_dwordx4 v[56:59], v14, s[20:23], s33 offen sc1
  s_add_u32 s32, s40, 2048
  s_add_u32 s33, s40, 18432
  buffer_load_dwordx4 v[24:27], v14, s[20:23], s32 offen sc1
  buffer_load_dwordx4 v[60:63], v14, s[20:23], s33 offen sc1
  s_add_u32 s32, s40, 4096
  s_add_u32 s33, s40, 20480
  buffer_load_dwordx4 v[28:31], v14, s[20:23], s32 offen sc1
  buffer_load_dwordx4 v[64:67], v14, s[20:23], s33 offen sc1
  s_add_u32 s32, s40, 6144
  s_add_u32 s33, s40, 22528
  buffer_load_dwordx4 v[32:35], v14, s[20:23], s32 offen sc1
  buffer_load_dwordx4 v[68:71], v14, s[20:23], s33 offen sc1
  s_waitcnt vmcnt(6)
  v_max3_u32 v5, v20, v21, v22
  v_max_u32 v5, v5, v23
  v_max3_u32 v5, v5, v56, v57
  v_max3_u32 v5, v5, v58, v59
  s_waitcnt vmcnt(4)
  v_max3_u32 v5, v5, v24, v25
  v_max3_u32 v5, v5, v26, v27
  v_max3_u32 v5, v5, v60, v61
  v_max3_u32 v5, v5, v62, v63
  s_waitcnt vmcnt(2)
  v_max3_u32 v5, v5, v28, v29
  v_max3_u32 v5, v5, v30, v31
  v_max3_u32 v5, v5, v64, v65
  v_max3_u32 v5, v5, v66, v67
  s_waitcnt vmcnt(0)
  v_max3_u32 v5, v5, v32, v33
  v_max3_u32 v5, v5, v34, v35
  v_max3_u32 v5, v5, v68, v69
  v_max3_u32 v5, v5, v70, v71
  v_cmp_eq_u32 vcc, -1, v5
  s_nop 1
  s_cmp_eq_u64 vcc, 0
  s_cbranch_scc1 L_SGVK0_OK
  s_add_u32 s50, s50, 1
  s_cmp_lt_u32 s50, 100000
  s_cbranch_scc1 L_SGVK0_L
L_SGVK0_OK:
  v_mov_b32 v5, 18428
  v_lshlrev_b32 v12, 11, v1
  v_add_u32 v12, v5, v12
  s_lshr_b32 s32, 0x55AA, s30
  s_bitcmp1_b32 s32, 0
  s_cbranch_scc0 L_SRK0_EARLY
  s_add_u32 s32, s40, 1024
  s_add_u32 s33, s40, 17408
  buffer_load_dwordx4 v[36:39], v14, s[20:23], s32 offen sc1
  buffer_load_dwordx4 v[72:75], v14, s[20:23], s33 offen sc1
  s_add_u32 s32, s40, 3072
  s_add_u32 s33, s40, 19456
  buffer_load_dwordx4 v[40:43], v14, s[20:23], s32 offen sc1
  buffer_load_dwordx4 v[76:79], v14, s[20:23], s33 offen sc1
  s_add_u32 s32, s40, 5120
  s_add_u32 s33, s40, 21504
  buffer_load_dwordx4 v[44:47], v14, s[20:23], s32 offen sc1
  buffer_load_dwordx4 v[80:83], v14, s[20:23], s33 offen sc1
  s_add_u32 s32, s40, 7168
  s_add_u32 s33, s40, 23552
  buffer_load_dwordx4 v[48:51], v14, s[20:23], s32 offen sc1
  buffer_load_dwordx4 v[84:87], v14, s[20:23], s33 offen sc1
  s_add_u32 s32, s40, 8192
  s_add_u32 s33, s40, 24576
  buffer_load_dwordx4 v[52:55], v14, s[20:23], s32 offen sc1
  buffer_load_dwordx4 v[88:91], v14, s[20:23], s33 offen sc1
  s_waitcnt lgkmcnt(0)
  v_mfma_f32_16x16x32_bf16 v[92:95], v[132:135], v[20:23], 0
  ds_read_b64_tr_b16 v[152:153], v10 offset:10368
  v_mfma_f32_16x16x32_bf16 v[112:115], v[132:135], v[56:59], 0
  ds_read_b64_tr_b16 v[154:155], v10 offset:10944
  v_mfma_f32_16x16x32_bf16 v[96:99], v[136:139], v[20:23], 0
  ds_read_b64_tr_b16 v[156:157], v10 offset:10400
  v_mfma_f32_16x16x32_bf16 v[116:119], v[136:139], v[56:59], 0
  ds_read_b64_tr_b16 v[158:159], v10 offset:10976
  v_mfma_f32_16x16x32_bf16 v[100:103], v[140:143], v[20:23], 0
  ds_read_b64_tr_b16 v[160:161], v10 offset:10432
  v_mfma_f32_16x16x32_bf16 v[120:123], v[140:143], v[56:59], 0
  ds_read_b64_tr_b16 v[162:163], v10 offset:11008
  v_mfma_f32_16x16x32_bf16 v[104:107], v[144:147], v[20:23], 0
  ds_read_b64_tr_b16 v[164:165], v10 offset:10464
  v_mfma_f32_16x16x32_bf16 v[124:127], v[144:147], v[56:59], 0
  ds_read_b64_tr_b16 v[166:167], v10 offset:11040
  v_mfma_f32_16x16x32_bf16 v[108:111], v[148:151], v[20:23], 0
  ds_read_b64_tr_b16 v[168:169], v10 offset:10496
  v_mfma_f32_16x16x32_bf16 v[128:131], v[148:151], v[56:59], 0
  ds_read_b64_tr_b16 v[170:171], v10 offset:11072
  s_waitcnt lgkmcnt(0)
  v_mfma_f32_16x16x32_bf16 v[92:95], v[152:155], v[24:27], v[92:95]
  ds_read_b64_tr_b16 v[132:133], v10 offset:20736
  v_mfma_f32_16x16x32_bf16 v[112:115], v[152:155], v[60:63], v[112:115]
  ds_read_b64_tr_b16 v[134:135], v10 offset:21312
  v_mfma_f32_16x16x32_bf16 v[96:99], v[156:159], v[24:27], v[96:99]
  ds_read_b64_tr_b16 v[136:137], v10 offset:20768
  v_mfma_f32_16x16x32_bf16 v[116:119], v[156:159], v[60:63], v[116:119]
  ds_read_b64_tr_b16 v[138:139], v10 offset:21344
  v_mfma_f32_16x16x32_bf16 v[100:103], v[160:163], v[24:27], v[100:103]
  ds_read_b64_tr_b16 v[140:141], v10 offset:20800
  v_mfma_f32_16x16x32_bf16 v[120:123], v[160:163], v[60:63], v[120:123]
  ds_read_b64_tr_b16 v[142:143], v10 offset:21376
  v_mfma_f32_16x16x32_bf16 v[104:107], v[164:167], v[24:27], v[104:107]
  ds_read_b64_tr_b16 v[144:145], v10 offset:20832
  v_mfma_f32_16x16x32_bf16 v[124:127], v[164:167], v[60:63], v[124:127]
  ds_read_b64_tr_b16 v[146:147], v10 offset:21408
  v_mfma_f32_16x16x32_bf16 v[108:111], v[168:171], v[24:27], v[108:111]
  ds_read_b64_tr_b16 v[148:149], v10 offset:20864
  v_mfma_f32_16x16x32_bf16 v[128:131], v[168:171], v[60:63], v[128:131]
  ds_read_b64_tr_b16 v[150:151], v10 offset:21440
  s_waitcnt lgkmcnt(0)
  v_mfma_f32_16x16x32_bf16 v[92:95], v[132:135], v[28:31], v[92:95]
  ds_read_b64_tr_b16 v[152:153], v10 offset:31104
  v_mfma_f32_16x16x32_bf16 v[112:115], v[132:135], v[64:67], v[112:115]
  ds_read_b64_tr_b16 v[154:155], v10 offset:31680
  v_mfma_f32_16x16x32_bf16 v[96:99], v[136:139], v[28:31], v[96:99]
  ds_read_b64_tr_b16 v[156:157], v10 offset:31136
  v_mfma_f32_16x16x32_bf16 v[116:119], v[136:139], v[64:67], v[116:119]
  ds_read_b64_tr_b16 v[158:159], v10 offset:31712
  v_mfma_f32_16x16x32_bf16 v[100:103], v[140:143], v[28:31], v[100:103]
  ds_read_b64_tr_b16 v[160:161], v10 offset:31168
  v_mfma_f32_16x16x32_bf16 v[120:123], v[140:143], v[64:67], v[120:123]
  ds_read_b64_tr_b16 v[162:163], v10 offset:31744
  v_mfma_f32_16x16x32_bf16 v[104:107], v[144:147], v[28:31], v[104:107]
  ds_read_b64_tr_b16 v[164:165], v10 offset:31200
  v_mfma_f32_16x16x32_bf16 v[124:127], v[144:147], v[64:67], v[124:127]
  ds_read_b64_tr_b16 v[166:167], v10 offset:31776
  v_mfma_f32_16x16x32_bf16 v[108:111], v[148:151], v[28:31], v[108:111]
  ds_read_b64_tr_b16 v[168:169], v10 offset:31232
  v_mfma_f32_16x16x32_bf16 v[128:131], v[148:151], v[64:67], v[128:131]
  ds_read_b64_tr_b16 v[170:171], v10 offset:31808
  s_waitcnt lgkmcnt(0)
  v_mfma_f32_16x16x32_bf16 v[92:95], v[152:155], v[32:35], v[92:95]
  ds_read_b64_tr_b16 v[132:133], v10 offset:5184
  v_mfma_f32_16x16x32_bf16 v[112:115], v[152:155], v[68:71], v[112:115]
  ds_read_b64_tr_b16 v[134:135], v10 offset:5760
  v_mfma_f32_16x16x32_bf16 v[96:99], v[156:159], v[32:35], v[96:99]
  ds_read_b64_tr_b16 v[136:137], v10 offset:5216
  v_mfma_f32_16x16x32_bf16 v[116:119], v[156:159], v[68:71], v[116:119]
  ds_read_b64_tr_b16 v[138:139], v10 offset:5792
  v_mfma_f32_16x16x32_bf16 v[100:103], v[160:163], v[32:35], v[100:103]
  ds_read_b64_tr_b16 v[140:141], v10 offset:5248
  v_mfma_f32_16x16x32_bf16 v[120:123], v[160:163], v[68:71], v[120:123]
  ds_read_b64_tr_b16 v[142:143], v10 offset:5824
  v_mfma_f32_16x16x32_bf16 v[104:107], v[164:167], v[32:35], v[104:107]
  ds_read_b64_tr_b16 v[144:145], v10 offset:5280
  v_mfma_f32_16x16x32_bf16 v[124:127], v[164:167], v[68:71], v[124:127]
  ds_read_b64_tr_b16 v[146:147], v10 offset:5856
  v_mfma_f32_16x16x32_bf16 v[108:111], v[168:171], v[32:35], v[108:111]
  ds_read_b64_tr_b16 v[148:149], v10 offset:5312
  v_mfma_f32_16x16x32_bf16 v[128:131], v[168:171], v[68:71], v[128:131]
  ds_read_b64_tr_b16 v[150:151], v10 offset:5888
  v_mov_b32 v2, 158748
  s_mov_b32 s60, 0
L_WOBK0:
  ds_read_b32 v3, v2
  s_add_u32 s60, s60, 1
  s_waitcnt lgkmcnt(0)
  v_readfirstlane_b32 s32, v3
  s_cmp_ge_u32 s32, 8
  s_cbranch_scc1 L_WOBK0_OK
  s_cmp_lt_u32 s60, 20000000
  s_cbranch_scc1 L_WOBK0
L_WOBK0_OK:
  s_waitcnt vmcnt(8)
  v_max3_u32 v5, v36, v37, v38
  v_max_u32 v5, v5, v39
  v_max3_u32 v5, v5, v72, v73
  v_max3_u32 v5, v5, v74, v75
  s_waitcnt vmcnt(6)
  v_max3_u32 v5, v5, v40, v41
  v_max3_u32 v5, v5, v42, v43
  v_max3_u32 v5, v5, v76, v77
  v_max3_u32 v5, v5, v78, v79
  s_waitcnt vmcnt(4)
  v_max3_u32 v5, v5, v44, v45
  v_max3_u32 v5, v5, v46, v47
  v_max3_u32 v5, v5, v80, v81
  v_max3_u32 v5, v5, v82, v83
  s_waitcnt vmcnt(2)
  v_max3_u32 v5, v5, v48, v49
  v_max3_u32 v5, v5, v50, v51
  v_max3_u32 v5, v5, v84, v85
  v_max3_u32 v5, v5, v86, v87
  s_waitcnt vmcnt(0)
  v_max3_u32 v5, v5, v52, v53
  v_max3_u32 v5, v5, v54, v55
  v_max3_u32 v5, v5, v88, v89
  v_max3_u32 v5, v5, v90, v91
  v_cmp_eq_u32 vcc, -1, v5
  s_nop 1
  s_cmp_eq_u64 vcc, 0
  s_cbranch_scc1 L_SRVK0_OK
  s_mov_b64 s[58:59], exec
  s_mov_b64 exec, 0xf
  s_mov_b32 s60, 0
L_SSK0_P:
  buffer_load_dword v9, v12, s[20:23], s40 offen sc1
L_SSK0_PW:
  s_add_u32 s60, s60, 1
  s_waitcnt vmcnt(0)
  v_cmp_eq_u32 vcc, -1, v9
  s_nop 1
  s_cmp_eq_u64 vcc, 0
  s_cbranch_scc1 L_SSK0_PO
  s_cmp_lt_u32 s60, 2000000
  s_cbranch_scc1 L_SSK0_P
L_SSK0_PO:
  s_mov_b64 exec, s[58:59]
  s_branch L_SRK0_LV
L_SRK0_EARLY:
  s_mov_b64 s[58:59], exec
  s_mov_b64 exec, 0xf
  buffer_load_dword v9, v12, s[20:23], s40 offen sc1
  s_mov_b64 exec, s[58:59]
  s_waitcnt lgkmcnt(0)
  v_mfma_f32_16x16x32_bf16 v[92:95], v[132:135], v[20:23], 0
  ds_read_b64_tr_b16 v[152:153], v10 offset:10368
  v_mfma_f32_16x16x32_bf16 v[112:115], v[132:135], v[56:59], 0
  ds_read_b64_tr_b16 v[154:155], v10 offset:10944
  v_mfma_f32_16x16x32_bf16 v[96:99], v[136:139], v[20:23], 0
  ds_read_b64_tr_b16 v[156:157], v10 offset:10400
  v_mfma_f32_16x16x32_bf16 v[116:119], v[136:139], v[56:59], 0
  ds_read_b64_tr_b16 v[158:159], v10 offset:10976
  v_mfma_f32_16x16x32_bf16 v[100:103], v[140:143], v[20:23], 0
  ds_read_b64_tr_b16 v[160:161], v10 offset:10432
  v_mfma_f32_16x16x32_bf16 v[120:123], v[140:143], v[56:59], 0
  ds_read_b64_tr_b16 v[162:163], v10 offset:11008
  v_mfma_f32_16x16x32_bf16 v[104:107], v[144:147], v[20:23], 0
  ds_read_b64_tr_b16 v[164:165], v10 offset:10464
  v_mfma_f32_16x16x32_bf16 v[124:127], v[144:147], v[56:59], 0
  ds_read_b64_tr_b16 v[166:167], v10 offset:11040
  v_mfma_f32_16x16x32_bf16 v[108:111], v[148:151], v[20:23], 0
  ds_read_b64_tr_b16 v[168:169], v10 offset:10496
  v_mfma_f32_16x16x32_bf16 v[128:131], v[148:151], v[56:59], 0
  ds_read_b64_tr_b16 v[170:171], v10 offset:11072
  s_waitcnt lgkmcnt(0)
  v_mfma_f32_16x16x32_bf16 v[92:95], v[152:155], v[24:27], v[92:95]
  ds_read_b64_tr_b16 v[132:133], v10 offset:20736
  v_mfma_f32_16x16x32_bf16 v[112:115], v[152:155], v[60:63], v[112:115]
  ds_read_b64_tr_b16 v[134:135], v10 offset:21312
  v_mfma_f32_16x16x32_bf16 v[96:99], v[156:159], v[24:27], v[96:99]
  ds_read_b64_tr_b16 v[136:137], v10 offset:20768
  v_mfma_f32_16x16x32_bf16 v[116:119], v[156:159], v[60:63], v[116:119]
  ds_read_b64_tr_b16 v[138:139], v10 offset:21344
  v_mfma_f32_16x16x32_bf16 v[100:103], v[160:163], v[24:27], v[100:103]
  ds_read_b64_tr_b16 v[140:141], v10 offset:20800
  v_mfma_f32_16x16x32_bf16 v[120:123], v[160:163], v[60:63], v[120:123]
  ds_read_b64_tr_b16 v[142:143], v10 offset:21376
  v_mfma_f32_16x16x32_bf16 v[104:107], v[164:167], v[24:27], v[104:107]
  ds_read_b64_tr_b16 v[144:145], v10 offset:20832
  v_mfma_f32_16x16x32_bf16 v[124:127], v[164:167], v[60:63], v[124:127]
  ds_read_b64_tr_b16 v[146:147], v10 offset:21408
  v_mfma_f32_16x16x32_bf16 v[108:111], v[168:171], v[24:27], v[108:111]
  ds_read_b64_tr_b16 v[148:149], v10 offset:20864
  v_mfma_f32_16x16x32_bf16 v[128:131], v[168:171], v[60:63], v[128:131]
  ds_read_b64_tr_b16 v[150:151], v10 offset:21440
  s_waitcnt lgkmcnt(0)
  v_mfma_f32_16x16x32_bf16 v[92:95], v[132:135], v[28:31], v[92:95]
  ds_read_b64_tr_b16 v[152:153], v10 offset:31104
  v_mfma_f32_16x16x32_bf16 v[112:115], v[132:135], v[64:67], v[112:115]
  ds_read_b64_tr_b16 v[154:155], v10 offset:31680
  v_mfma_f32_16x16x32_bf16 v[96:99], v[136:139], v[28:31], v[96:99]
  ds_read_b64_tr_b16 v[156:157], v10 offset:31136
  v_mfma_f32_16x16x32_bf16 v[116:119], v[136:139], v[64:67], v[116:119]
  ds_read_b64_tr_b16 v[158:159], v10 offset:31712
  v_mfma_f32_16x16x32_bf16 v[100:103], v[140:143], v[28:31], v[100:103]
  ds_read_b64_tr_b16 v[160:161], v10 offset:31168
  v_mfma_f32_16x16x32_bf16 v[120:123], v[140:143], v[64:67], v[120:123]
  ds_read_b64_tr_b16 v[162:163], v10 offset:31744
  v_mfma_f32_16x16x32_bf16 v[104:107], v[144:147], v[28:31], v[104:107]
  ds_read_b64_tr_b16 v[164:165], v10 offset:31200
  v_mfma_f32_16x16x32_bf16 v[124:127], v[144:147], v[64:67], v[124:127]
  ds_read_b64_tr_b16 v[166:167], v10 offset:31776
  v_mfma_f32_16x16x32_bf16 v[108:111], v[148:151], v[28:31], v[108:111]
  ds_read_b64_tr_b16 v[168:169], v10 offset:31232
  v_mfma_f32_16x16x32_bf16 v[128:131], v[148:151], v[64:67], v[128:131]
  ds_read_b64_tr_b16 v[170:171], v10 offset:31808
  s_waitcnt lgkmcnt(0)
  v_mfma_f32_16x16x32_bf16 v[92:95], v[152:155], v[32:35], v[92:95]
  ds_read_b64_tr_b16 v[132:133], v10 offset:5184
  v_mfma_f32_16x16x32_bf16 v[112:115], v[152:155], v[68:71], v[112:115]
  ds_read_b64_tr_b16 v[134:135], v10 offset:5760
  v_mfma_f32_16x16x32_bf16 v[96:99], v[156:159], v[32:35], v[96:99]
  ds_read_b64_tr_b16 v[136:137], v10 offset:5216
  v_mfma_f32_16x16x32_bf16 v[116:119], v[156:159], v[68:71], v[116:119]
  ds_read_b64_tr_b16 v[138:139], v10 offset:5792
  v_mfma_f32_16x16x32_bf16 v[100:103], v[160:163], v[32:35], v[100:103]
  ds_read_b64_tr_b16 v[140:141], v10 offset:5248
  v_mfma_f32_16x16x32_bf16 v[120:123], v[160:163], v[68:71], v[120:123]
  ds_read_b64_tr_b16 v[142:143], v10 offset:5824
  v_mfma_f32_16x16x32_bf16 v[104:107], v[164:167], v[32:35], v[104:107]
  ds_read_b64_tr_b16 v[144:145], v10 offset:5280
  v_mfma_f32_16x16x32_bf16 v[124:127], v[164:167], v[68:71], v[124:127]
  ds_read_b64_tr_b16 v[146:147], v10 offset:5856
  v_mfma_f32_16x16x32_bf16 v[108:111], v[168:171], v[32:35], v[108:111]
  ds_read_b64_tr_b16 v[148:149], v10 offset:5312
  v_mfma_f32_16x16x32_bf16 v[128:131], v[168:171], v[68:71], v[128:131]
  ds_read_b64_tr_b16 v[150:151], v10 offset:5888
  v_mov_b32 v2, 158748
  s_mov_b32 s60, 0
L_WOAK0:
  ds_read_b32 v3, v2
  s_add_u32 s60, s60, 1
  s_waitcnt lgkmcnt(0)
  v_readfirstlane_b32 s32, v3
  s_cmp_ge_u32 s32, 8
  s_cbranch_scc1 L_WOAK0_OK
  s_cmp_lt_u32 s60, 20000000
  s_cbranch_scc1 L_WOAK0
L_WOAK0_OK:
  s_mov_b64 s[58:59], exec
  s_mov_b64 exec, 0xf
  s_mov_b32 s60, 0
  s_branch L_SRK0_PW
L_SRK0_P:
  buffer_load_dword v9, v12, s[20:23], s40 offen sc1
L_SRK0_PW:
  s_add_u32 s60, s60, 1
  s_waitcnt vmcnt(0)
  v_cmp_eq_u32 vcc, -1, v9
  s_nop 1
  s_cmp_eq_u64 vcc, 0
  s_cbranch_scc1 L_SRK0_PO
  s_cmp_lt_u32 s60, 2000000
  s_cbranch_scc1 L_SRK0_P
L_SRK0_PO:
  s_mov_b64 exec, s[58:59]
L_SRK0_LV:
  s_mov_b32 s50, 0
L_SRVK0_L:
  s_add_u32 s32, s40, 1024
  s_add_u32 s33, s40, 17408
  buffer_load_dwordx4 v[36:39], v14, s[20:23], s32 offen sc1
  buffer_load_dwordx4 v[72:75], v14, s[20:23], s33 offen sc1
  s_add_u32 s32, s40, 3072
  s_add_u32 s33, s40, 19456
  buffer_load_dwordx4 v[40:43], v14, s[20:23], s32 offen sc1
  buffer_load_dwordx4 v[76:79], v14, s[20:23], s33 offen sc1
  s_add_u32 s32, s40, 5120
  s_add_u32 s33, s40, 21504
  buffer_load_dwordx4 v[44:47], v14, s[20:23], s32 offen sc1
  buffer_load_dwordx4 v[80:83], v14, s[20:23], s33 offen sc1
  s_add_u32 s32, s40, 7168
  s_add_u32 s33, s40, 23552
  buffer_load_dwordx4 v[48:51], v14, s[20:23], s32 offen sc1
  buffer_load_dwordx4 v[84:87], v14, s[20:23], s33 offen sc1
  s_add_u32 s32, s40, 8192
  s_add_u32 s33, s40, 24576
  buffer_load_dwordx4 v[52:55], v14, s[20:23], s32 offen sc1
  buffer_load_dwordx4 v[88:91], v14, s[20:23], s33 offen sc1
  s_waitcnt vmcnt(8)
  v_max3_u32 v5, v36, v37, v38
  v_max_u32 v5, v5, v39
  v_max3_u32 v5, v5, v72, v73
  v_max3_u32 v5, v5, v74, v75
  s_waitcnt vmcnt(6)
  v_max3_u32 v5, v5, v40, v41
  v_max3_u32 v5, v5, v42, v43
  v_max3_u32 v5, v5, v76, v77
  v_max3_u32 v5, v5, v78, v79
  s_waitcnt vmcnt(4)
  v_max3_u32 v5, v5, v44, v45
  v_max3_u32 v5, v5, v46, v47
  v_max3_u32 v5, v5, v80, v81
  v_max3_u32 v5, v5, v82, v83
  s_waitcnt vmcnt(2)
  v_max3_u32 v5, v5, v48, v49
  v_max3_u32 v5, v5, v50, v51
  v_max3_u32 v5, v5, v84, v85
  v_max3_u32 v5, v5, v86, v87
  s_waitcnt vmcnt(0)
  v_max3_u32 v5, v5, v52, v53
  v_max3_u32 v5, v5, v54, v55
  v_max3_u32 v5, v5, v88, v89
  v_max3_u32 v5, v5, v90, v91
  v_cmp_eq_u32 vcc, -1, v5
  s_nop 1
  s_cmp_eq_u64 vcc, 0
  s_cbranch_scc1 L_SRVK0_OK
  s_add_u32 s50, s50, 1
  s_cmp_lt_u32 s50, 100000
  s_cbranch_scc1 L_SRVK0_L
L_SRVK0_OK:
  s_waitcnt lgkmcnt(0)
  v_mfma_f32_16x16x32_bf16 v[92:95], v[132:135], v[36:39], v[92:95]
  ds_read_b64_tr_b16 v[152:153], v10 offset:15552
  v_mfma_f32_16x16x32_bf16 v[112:115], v[132:135], v[72:75], v[112:115]
  ds_read_b64_tr_b16 v[154:155], v10 offset:16128
  v_mfma_f32_16x16x32_bf16 v[96:99], v[136:139], v[36:39], v[96:99]
  ds_read_b64_tr_b16 v[156:157], v10 offset:15584
  v_mfma_f32_16x16x32_bf16 v[116:119], v[136:139], v[72:75], v[116:119]
  ds_read_b64_tr_b16 v[158:159], v10 offset:16160
  v_mfma_f32_16x16x32_bf16 v[100:103], v[140:143], v[36:39], v[100:103]
  ds_read_b64_tr_b16 v[160:161], v10 offset:15616
  v_mfma_f32_16x16x32_bf16 v[120:123], v[140:143], v[72:75], v[120:123]
  ds_read_b64_tr_b16 v[162:163], v10 offset:16192
  v_mfma_f32_16x16x32_bf16 v[104:107], v[144:147], v[36:39], v[104:107]
  ds_read_b64_tr_b16 v[164:165], v10 offset:15648
  v_mfma_f32_16x16x32_bf16 v[124:127], v[144:147], v[72:75], v[124:127]
  ds_read_b64_tr_b16 v[166:167], v10 offset:16224
  v_mfma_f32_16x16x32_bf16 v[108:111], v[148:151], v[36:39], v[108:111]
  ds_read_b64_tr_b16 v[168:169], v10 offset:15680
  v_mfma_f32_16x16x32_bf16 v[128:131], v[148:151], v[72:75], v[128:131]
  ds_read_b64_tr_b16 v[170:171], v10 offset:16256
  s_waitcnt lgkmcnt(0)
  v_mfma_f32_16x16x32_bf16 v[92:95], v[152:155], v[40:43], v[92:95]
  ds_read_b64_tr_b16 v[132:133], v10 offset:25920
  v_mfma_f32_16x16x32_bf16 v[112:115], v[152:155], v[76:79], v[112:115]
  ds_read_b64_tr_b16 v[134:135], v10 offset:26496
  v_mfma_f32_16x16x32_bf16 v[96:99], v[156:159], v[40:43], v[96:99]
  ds_read_b64_tr_b16 v[136:137], v10 offset:25952
  v_mfma_f32_16x16x32_bf16 v[116:119], v[156:159], v[76:79], v[116:119]
  ds_read_b64_tr_b16 v[138:139], v10 offset:26528
  v_mfma_f32_16x16x32_bf16 v[100:103], v[160:163], v[40:43], v[100:103]
  ds_read_b64_tr_b16 v[140:141], v10 offset:25984
  v_mfma_f32_16x16x32_bf16 v[120:123], v[160:163], v[76:79], v[120:123]
  ds_read_b64_tr_b16 v[142:143], v10 offset:26560
  v_mfma_f32_16x16x32_bf16 v[104:107], v[164:167], v[40:43], v[104:107]
  ds_read_b64_tr_b16 v[144:145], v10 offset:26016
  v_mfma_f32_16x16x32_bf16 v[124:127], v[164:167], v[76:79], v[124:127]
  ds_read_b64_tr_b16 v[146:147], v10 offset:26592
  v_mfma_f32_16x16x32_bf16 v[108:111], v[168:171], v[40:43], v[108:111]
  ds_read_b64_tr_b16 v[148:149], v10 offset:26048
  v_mfma_f32_16x16x32_bf16 v[128:131], v[168:171], v[76:79], v[128:131]
  ds_read_b64_tr_b16 v[150:151], v10 offset:26624
  s_waitcnt lgkmcnt(0)
  v_mfma_f32_16x16x32_bf16 v[92:95], v[132:135], v[44:47], v[92:95]
  ds_read_b64_tr_b16 v[152:153], v10 offset:36288
  v_mfma_f32_16x16x32_bf16 v[112:115], v[132:135], v[80:83], v[112:115]
  ds_read_b64_tr_b16 v[154:155], v10 offset:36864
  v_mfma_f32_16x16x32_bf16 v[96:99], v[136:139], v[44:47], v[96:99]
  ds_read_b64_tr_b16 v[156:157], v10 offset:36320
  v_mfma_f32_16x16x32_bf16 v[116:119], v[136:139], v[80:83], v[116:119]
  ds_read_b64_tr_b16 v[158:159], v10 offset:36896
  v_mfma_f32_16x16x32_bf16 v[100:103], v[140:143], v[44:47], v[100:103]
  ds_read_b64_tr_b16 v[160:161], v10 offset:36352
  v_mfma_f32_16x16x32_bf16 v[120:123], v[140:143], v[80:83], v[120:123]
  ds_read_b64_tr_b16 v[162:163], v10 offset:36928
  v_mfma_f32_16x16x32_bf16 v[104:107], v[144:147], v[44:47], v[104:107]
  ds_read_b64_tr_b16 v[164:165], v10 offset:36384
  v_mfma_f32_16x16x32_bf16 v[124:127], v[144:147], v[80:83], v[124:127]
  ds_read_b64_tr_b16 v[166:167], v10 offset:36960
  v_mfma_f32_16x16x32_bf16 v[108:111], v[148:151], v[44:47], v[108:111]
  ds_read_b64_tr_b16 v[168:169], v10 offset:36416
  v_mfma_f32_16x16x32_bf16 v[128:131], v[148:151], v[80:83], v[128:131]
  ds_read_b64_tr_b16 v[170:171], v10 offset:36992
  s_waitcnt lgkmcnt(0)
  v_mfma_f32_16x16x32_bf16 v[92:95], v[152:155], v[48:51], v[92:95]
  ds_read_b64_tr_b16 v[132:133], v10 offset:41472
  v_mfma_f32_16x16x32_bf16 v[112:115], v[152:155], v[84:87], v[112:115]
  ds_read_b64_tr_b16 v[134:135], v10 offset:42048
  v_mfma_f32_16x16x32_bf16 v[96:99], v[156:159], v[48:51], v[96:99]
  ds_read_b64_tr_b16 v[136:137], v10 offset:41504
  v_mfma_f32_16x16x32_bf16 v[116:119], v[156:159], v[84:87], v[116:119]
  ds_read_b64_tr_b16 v[138:139], v10 offset:42080
  v_mfma_f32_16x16x32_bf16 v[100:103], v[160:163], v[48:51], v[100:103]
  ds_read_b64_tr_b16 v[140:141], v10 offset:41536
  v_mfma_f32_16x16x32_bf16 v[120:123], v[160:163], v[84:87], v[120:123]
  ds_read_b64_tr_b16 v[142:143], v10 offset:42112
  v_mfma_f32_16x16x32_bf16 v[104:107], v[164:167], v[48:51], v[104:107]
  ds_read_b64_tr_b16 v[144:145], v10 offset:41568
  v_mfma_f32_16x16x32_bf16 v[124:127], v[164:167], v[84:87], v[124:127]
  ds_read_b64_tr_b16 v[146:147], v10 offset:42144
  v_mfma_f32_16x16x32_bf16 v[108:111], v[168:171], v[48:51], v[108:111]
  ds_read_b64_tr_b16 v[148:149], v10 offset:41600
  v_mfma_f32_16x16x32_bf16 v[128:131], v[168:171], v[84:87], v[128:131]
  ds_read_b64_tr_b16 v[150:151], v10 offset:42176
  s_waitcnt lgkmcnt(0)
  v_mfma_f32_16x16x32_bf16 v[92:95], v[132:135], v[52:55], v[92:95]
  v_mfma_f32_16x16x32_bf16 v[112:115], v[132:135], v[88:91], v[112:115]
  v_mfma_f32_16x16x32_bf16 v[96:99], v[136:139], v[52:55], v[96:99]
  v_mfma_f32_16x16x32_bf16 v[116:119], v[136:139], v[88:91], v[116:119]
  v_mfma_f32_16x16x32_bf16 v[100:103], v[140:143], v[52:55], v[100:103]
  v_mfma_f32_16x16x32_bf16 v[120:123], v[140:143], v[88:91], v[120:123]
  v_mfma_f32_16x16x32_bf16 v[104:107], v[144:147], v[52:55], v[104:107]
  v_mfma_f32_16x16x32_bf16 v[124:127], v[144:147], v[88:91], v[124:127]
  v_mfma_f32_16x16x32_bf16 v[108:111], v[148:151], v[52:55], v[108:111]
  v_mfma_f32_16x16x32_bf16 v[128:131], v[148:151], v[88:91], v[128:131]
  s_nop 7
  ds_write_b128 v18, v[112:115] offset:0
  ds_write_b128 v18, v[116:119] offset:1024
  ds_write_b128 v18, v[120:123] offset:2048
  ds_write_b128 v18, v[124:127] offset:3072
  ds_write_b128 v18, v[128:131] offset:4096
  s_waitcnt lgkmcnt(0)
  s_barrier
  ds_read_b128 v[20:23], v19 offset:0
  ds_read_b128 v[24:27], v19 offset:1024
  ds_read_b128 v[28:31], v19 offset:2048
  ds_read_b128 v[32:35], v19 offset:3072
  ds_read_b128 v[36:39], v19 offset:4096
  s_waitcnt lgkmcnt(4)
  v_add_f32 v20, v20, v92
  v_add_f32 v21, v21, v93
  v_add_f32 v22, v22, v94
  v_add_f32 v23, v23, v95
  v_cvt_pk_bf16_f32 v40, v20, v21
  v_cvt_pk_bf16_f32 v41, v22, v23
  buffer_store_dwordx2 v[40:41], v15, s[24:27], s37 offen offset:0
  s_waitcnt lgkmcnt(3)
  v_add_f32 v24, v24, v96
  v_add_f32 v25, v25, v97
  v_add_f32 v26, v26, v98
  v_add_f32 v27, v27, v99
  v_cvt_pk_bf16_f32 v42, v24, v25
  v_cvt_pk_bf16_f32 v43, v26, v27
  buffer_store_dwordx2 v[42:43], v15, s[24:27], s37 offen offset:32
  s_waitcnt lgkmcnt(2)
  v_add_f32 v28, v28, v100
  v_add_f32 v29, v29, v101
  v_add_f32 v30, v30, v102
  v_add_f32 v31, v31, v103
  v_cvt_pk_bf16_f32 v44, v28, v29
  v_cvt_pk_bf16_f32 v45, v30, v31
  buffer_store_dwordx2 v[44:45], v15, s[24:27], s37 offen offset:64
  s_waitcnt lgkmcnt(1)
  v_add_f32 v32, v32, v104
  v_add_f32 v33, v33, v105
  v_add_f32 v34, v34, v106
  v_add_f32 v35, v35, v107
  v_cvt_pk_bf16_f32 v46, v32, v33
  v_cvt_pk_bf16_f32 v47, v34, v35
  buffer_store_dwordx2 v[46:47], v15, s[24:27], s37 offen offset:96
  s_waitcnt lgkmcnt(0)
  v_add_f32 v36, v36, v108
  v_add_f32 v37, v37, v109
  v_add_f32 v38, v38, v110
  v_add_f32 v39, v39, v111
  v_cvt_pk_bf16_f32 v48, v36, v37
  v_cvt_pk_bf16_f32 v49, v38, v39
  s_mov_b64 s[58:59], exec
  s_mov_b32 exec_hi, 0
  buffer_store_dwordx2 v[48:49], v15, s[24:27], s37 offen offset:128
  s_mov_b64 exec, s[58:59]
  s_branch L_FIN
L_P3K1:
  ds_read_b64_tr_b16 v[132:133], v10 offset:0
  ds_read_b64_tr_b16 v[134:135], v10 offset:576
  ds_read_b64_tr_b16 v[136:137], v10 offset:32
  ds_read_b64_tr_b16 v[138:139], v10 offset:608
  ds_read_b64_tr_b16 v[140:141], v10 offset:64
  ds_read_b64_tr_b16 v[142:143], v10 offset:640
  ds_read_b64_tr_b16 v[144:145], v10 offset:96
  ds_read_b64_tr_b16 v[146:147], v10 offset:672
  ds_read_b64_tr_b16 v[148:149], v10 offset:128
  ds_read_b64_tr_b16 v[150:151], v10 offset:704
  s_lshr_b32 s32, 0x55AA, s30
  s_bitcmp1_b32 s32, 0
  s_cbranch_scc1 L_SGK1_GO
  v_mov_b32 v5, 26620
  v_lshlrev_b32 v12, 11, v1
  v_add_u32 v12, v5, v12
  s_mov_b64 s[58:59], exec
  s_mov_b64 exec, 0xf
  s_mov_b32 s60, 0
L_SGK1_P:
  buffer_load_dword v9, v12, s[20:23], s40 offen sc1
L_SGK1_PW:
  s_add_u32 s60, s60, 1
  s_waitcnt vmcnt(0)
  v_cmp_eq_u32 vcc, -1, v9
  s_nop 1
  s_cmp_eq_u64 vcc, 0
  s_cbranch_scc1 L_SGK1_PO
  s_cmp_lt_u32 s60, 2000000
  s_cbranch_scc1 L_SGK1_P
L_SGK1_PO:
  s_mov_b64 exec, s[58:59]
L_SGK1_GO:
  s_mov_b32 s50, 0
L_SGVK1_L:
  s_add_u32 s32, s40, 9216
  s_add_u32 s33, s40, 25600
  buffer_load_dwordx4 v[20:23], v14, s[20:23], s32 offen sc1
  buffer_load_dwordx4 v[56:59], v14, s[20:23], s33 offen sc1
  s_add_u32 s32, s40, 11264
  s_add_u32 s33, s40, 27648
  buffer_load_dwordx4 v[24:27], v14, s[20:23], s32 offen sc1
  buffer_load_dwordx4 v[60:63], v14, s[20:23], s33 offen sc1
  s_add_u32 s32, s40, 13312
  s_add_u32 s33, s40, 29696
  buffer_load_dwordx4 v[28:31], v14, s[20:23], s32 offen sc1
  buffer_load_dwordx4 v[64:67], v14, s[20:23], s33 offen sc1
  s_add_u32 s32, s40, 15360
  s_add_u32 s33, s40, 31744
  buffer_load_dwordx4 v[32:35], v14, s[20:23], s32 offen sc1
  buffer_load_dwordx4 v[68:71], v14, s[20:23], s33 offen sc1
  s_waitcnt vmcnt(6)
  v_max3_u32 v5, v20, v21, v22
  v_max_u32 v5, v5, v23
  v_max3_u32 v5, v5, v56, v57
  v_max3_u32 v5, v5, v58, v59
  s_waitcnt vmcnt(4)
  v_max3_u32 v5, v5, v24, v25
  v_max3_u32 v5, v5, v26, v27
  v_max3_u32 v5, v5, v60, v61
  v_max3_u32 v5, v5, v62, v63
  s_waitcnt vmcnt(2)
  v_max3_u32 v5, v5, v28, v29
  v_max3_u32 v5, v5, v30, v31
  v_max3_u32 v5, v5, v64, v65
  v_max3_u32 v5, v5, v66, v67
  s_waitcnt vmcnt(0)
  v_max3_u32 v5, v5, v32, v33
  v_max3_u32 v5, v5, v34, v35
  v_max3_u32 v5, v5, v68, v69
  v_max3_u32 v5, v5, v70, v71
  v_cmp_eq_u32 vcc, -1, v5
  s_nop 1
  s_cmp_eq_u64 vcc, 0
  s_cbranch_scc1 L_SGVK1_OK
  s_add_u32 s50, s50, 1
  s_cmp_lt_u32 s50, 100000
  s_cbranch_scc1 L_SGVK1_L
L_SGVK1_OK:
  v_mov_b32 v5, 27644
  v_lshlrev_b32 v12, 11, v1
  v_add_u32 v12, v5, v12
  s_lshr_b32 s32, 0x55AA, s30
  s_bitcmp1_b32 s32, 0
  s_cbranch_scc0 L_SRK1_EARLY
  s_add_u32 s32, s40, 10240
  s_add_u32 s33, s40, 26624
  buffer_load_dwordx4 v[36:39], v14, s[20:23], s32 offen sc1
  buffer_load_dwordx4 v[72:75], v14, s[20:23], s33 offen sc1
  s_add_u32 s32, s40, 12288
  s_add_u32 s33, s40, 28672
  buffer_load_dwordx4 v[40:43], v14, s[20:23], s32 offen sc1
  buffer_load_dwordx4 v[76:79], v14, s[20:23], s33 offen sc1
  s_add_u32 s32, s40, 14336
  s_add_u32 s33, s40, 30720
  buffer_load_dwordx4 v[44:47], v14, s[20:23], s32 offen sc1
  buffer_load_dwordx4 v[80:83], v14, s[20:23], s33 offen sc1
  s_add_u32 s32, s68, 0
  buffer_load_dword v48, v16, s[20:23], s32 offen offset:0 sc1
  buffer_load_dword v49, v16, s[20:23], s32 offen offset:1024 sc1
  buffer_load_dword v50, v16, s[20:23], s32 offen offset:2048 sc1
  buffer_load_dword v51, v16, s[20:23], s32 offen offset:3072 sc1
  buffer_load_dword v84, v17, s[20:23], s32 offen offset:0 sc1
  buffer_load_dword v85, v17, s[20:23], s32 offen offset:1024 sc1
  buffer_load_dword v86, v17, s[20:23], s32 offen offset:2048 sc1
  buffer_load_dword v87, v17, s[20:23], s32 offen offset:3072 sc1
  s_add_u32 s32, s68, 16384
  buffer_load_dword v52, v16, s[20:23], s32 offen offset:0 sc1
  buffer_load_dword v53, v16, s[20:23], s32 offen offset:1024 sc1
  buffer_load_dword v54, v16, s[20:23], s32 offen offset:2048 sc1
  buffer_load_dword v55, v16, s[20:23], s32 offen offset:3072 sc1
  buffer_load_dword v88, v17, s[20:23], s32 offen offset:0 sc1
  buffer_load_dword v89, v17, s[20:23], s32 offen offset:1024 sc1
  buffer_load_dword v90, v17, s[20:23], s32 offen offset:2048 sc1
  buffer_load_dword v91, v17, s[20:23], s32 offen offset:3072 sc1
  s_waitcnt lgkmcnt(0)
  v_mfma_f32_16x16x32_bf16 v[92:95], v[132:135], v[20:23], 0
  ds_read_b64_tr_b16 v[152:153], v10 offset:10368
  v_mfma_f32_16x16x32_bf16 v[112:115], v[132:135], v[56:59], 0
  ds_read_b64_tr_b16 v[154:155], v10 offset:10944
  v_mfma_f32_16x16x32_bf16 v[96:99], v[136:139], v[20:23], 0
  ds_read_b64_tr_b16 v[156:157], v10 offset:10400
  v_mfma_f32_16x16x32_bf16 v[116:119], v[136:139], v[56:59], 0
  ds_read_b64_tr_b16 v[158:159], v10 offset:10976
  v_mfma_f32_16x16x32_bf16 v[100:103], v[140:143], v[20:23], 0
  ds_read_b64_tr_b16 v[160:161], v10 offset:10432
  v_mfma_f32_16x16x32_bf16 v[120:123], v[140:143], v[56:59], 0
  ds_read_b64_tr_b16 v[162:163], v10 offset:11008
  v_mfma_f32_16x16x32_bf16 v[104:107], v[144:147], v[20:23], 0
  ds_read_b64_tr_b16 v[164:165], v10 offset:10464
  v_mfma_f32_16x16x32_bf16 v[124:127], v[144:147], v[56:59], 0
  ds_read_b64_tr_b16 v[166:167], v10 offset:11040
  v_mfma_f32_16x16x32_bf16 v[108:111], v[148:151], v[20:23], 0
  ds_read_b64_tr_b16 v[168:169], v10 offset:10496
  v_mfma_f32_16x16x32_bf16 v[128:131], v[148:151], v[56:59], 0
  ds_read_b64_tr_b16 v[170:171], v10 offset:11072
  s_waitcnt lgkmcnt(0)
  v_mfma_f32_16x16x32_bf16 v[92:95], v[152:155], v[24:27], v[92:95]
  ds_read_b64_tr_b16 v[132:133], v10 offset:20736
  v_mfma_f32_16x16x32_bf16 v[112:115], v[152:155], v[60:63], v[112:115]
  ds_read_b64_tr_b16 v[134:135], v10 offset:21312
  v_mfma_f32_16x16x32_bf16 v[96:99], v[156:159], v[24:27], v[96:99]
  ds_read_b64_tr_b16 v[136:137], v10 offset:20768
  v_mfma_f32_16x16x32_bf16 v[116:119], v[156:159], v[60:63], v[116:119]
  ds_read_b64_tr_b16 v[138:139], v10 offset:21344
  v_mfma_f32_16x16x32_bf16 v[100:103], v[160:163], v[24:27], v[100:103]
  ds_read_b64_tr_b16 v[140:141], v10 offset:20800
  v_mfma_f32_16x16x32_bf16 v[120:123], v[160:163], v[60:63], v[120:123]
  ds_read_b64_tr_b16 v[142:143], v10 offset:21376
  v_mfma_f32_16x16x32_bf16 v[104:107], v[164:167], v[24:27], v[104:107]
  ds_read_b64_tr_b16 v[144:145], v10 offset:20832
  v_mfma_f32_16x16x32_bf16 v[124:127], v[164:167], v[60:63], v[124:127]
  ds_read_b64_tr_b16 v[146:147], v10 offset:21408
  v_mfma_f32_16x16x32_bf16 v[108:111], v[168:171], v[24:27], v[108:111]
  ds_read_b64_tr_b16 v[148:149], v10 offset:20864
  v_mfma_f32_16x16x32_bf16 v[128:131], v[168:171], v[60:63], v[128:131]
  ds_read_b64_tr_b16 v[150:151], v10 offset:21440
  s_waitcnt lgkmcnt(0)
  v_mfma_f32_16x16x32_bf16 v[92:95], v[132:135], v[28:31], v[92:95]
  ds_read_b64_tr_b16 v[152:153], v10 offset:31104
  v_mfma_f32_16x16x32_bf16 v[112:115], v[132:135], v[64:67], v[112:115]
  ds_read_b64_tr_b16 v[154:155], v10 offset:31680
  v_mfma_f32_16x16x32_bf16 v[96:99], v[136:139], v[28:31], v[96:99]
  ds_read_b64_tr_b16 v[156:157], v10 offset:31136
  v_mfma_f32_16x16x32_bf16 v[116:119], v[136:139], v[64:67], v[116:119]
  ds_read_b64_tr_b16 v[158:159], v10 offset:31712
  v_mfma_f32_16x16x32_bf16 v[100:103], v[140:143], v[28:31], v[100:103]
  ds_read_b64_tr_b16 v[160:161], v10 offset:31168
  v_mfma_f32_16x16x32_bf16 v[120:123], v[140:143], v[64:67], v[120:123]
  ds_read_b64_tr_b16 v[162:163], v10 offset:31744
  v_mfma_f32_16x16x32_bf16 v[104:107], v[144:147], v[28:31], v[104:107]
  ds_read_b64_tr_b16 v[164:165], v10 offset:31200
  v_mfma_f32_16x16x32_bf16 v[124:127], v[144:147], v[64:67], v[124:127]
  ds_read_b64_tr_b16 v[166:167], v10 offset:31776
  v_mfma_f32_16x16x32_bf16 v[108:111], v[148:151], v[28:31], v[108:111]
  ds_read_b64_tr_b16 v[168:169], v10 offset:31232
  v_mfma_f32_16x16x32_bf16 v[128:131], v[148:151], v[64:67], v[128:131]
  ds_read_b64_tr_b16 v[170:171], v10 offset:31808
  s_waitcnt lgkmcnt(0)
  v_mfma_f32_16x16x32_bf16 v[92:95], v[152:155], v[32:35], v[92:95]
  ds_read_b64_tr_b16 v[132:133], v10 offset:5184
  v_mfma_f32_16x16x32_bf16 v[112:115], v[152:155], v[68:71], v[112:115]
  ds_read_b64_tr_b16 v[134:135], v10 offset:5760
  v_mfma_f32_16x16x32_bf16 v[96:99], v[156:159], v[32:35], v[96:99]
  ds_read_b64_tr_b16 v[136:137], v10 offset:5216
  v_mfma_f32_16x16x32_bf16 v[116:119], v[156:159], v[68:71], v[116:119]
  ds_read_b64_tr_b16 v[138:139], v10 offset:5792
  v_mfma_f32_16x16x32_bf16 v[100:103], v[160:163], v[32:35], v[100:103]
  ds_read_b64_tr_b16 v[140:141], v10 offset:5248
  v_mfma_f32_16x16x32_bf16 v[120:123], v[160:163], v[68:71], v[120:123]
  ds_read_b64_tr_b16 v[142:143], v10 offset:5824
  v_mfma_f32_16x16x32_bf16 v[104:107], v[164:167], v[32:35], v[104:107]
  ds_read_b64_tr_b16 v[144:145], v10 offset:5280
  v_mfma_f32_16x16x32_bf16 v[124:127], v[164:167], v[68:71], v[124:127]
  ds_read_b64_tr_b16 v[146:147], v10 offset:5856
  v_mfma_f32_16x16x32_bf16 v[108:111], v[168:171], v[32:35], v[108:111]
  ds_read_b64_tr_b16 v[148:149], v10 offset:5312
  v_mfma_f32_16x16x32_bf16 v[128:131], v[168:171], v[68:71], v[128:131]
  ds_read_b64_tr_b16 v[150:151], v10 offset:5888
  v_mov_b32 v2, 158748
  s_mov_b32 s60, 0
L_WOBK1:
  ds_read_b32 v3, v2
  s_add_u32 s60, s60, 1
  s_waitcnt lgkmcnt(0)
  v_readfirstlane_b32 s32, v3
  s_cmp_ge_u32 s32, 8
  s_cbranch_scc1 L_WOBK1_OK
  s_cmp_lt_u32 s60, 20000000
  s_cbranch_scc1 L_WOBK1
L_WOBK1_OK:
  s_waitcnt vmcnt(20)
  v_max3_u32 v5, v36, v37, v38
  v_max_u32 v5, v5, v39
  v_max3_u32 v5, v5, v72, v73
  v_max3_u32 v5, v5, v74, v75
  s_waitcnt vmcnt(18)
  v_max3_u32 v5, v5, v40, v41
  v_max3_u32 v5, v5, v42, v43
  v_max3_u32 v5, v5, v76, v77
  v_max3_u32 v5, v5, v78, v79
  s_waitcnt vmcnt(16)
  v_max3_u32 v5, v5, v44, v45
  v_max3_u32 v5, v5, v46, v47
  v_max3_u32 v5, v5, v80, v81
  v_max3_u32 v5, v5, v82, v83
  s_waitcnt vmcnt(8)
  v_max3_u32 v5, v5, v48, v49
  v_max3_u32 v5, v5, v50, v51
  v_max3_u32 v5, v5, v84, v85
  v_max3_u32 v5, v5, v86, v87
  s_waitcnt vmcnt(0)
  v_max3_u32 v5, v5, v52, v53
  v_max3_u32 v5, v5, v54, v55
  v_max3_u32 v5, v5, v88, v89
  v_max3_u32 v5, v5, v90, v91
  v_cmp_eq_u32 vcc, -1, v5
  s_nop 1
  s_cmp_eq_u64 vcc, 0
  s_cbranch_scc1 L_SRVK1_OK
  s_mov_b64 s[58:59], exec
  s_mov_b64 exec, 0x7
  s_mov_b32 s60, 0
L_SSK1_P:
  buffer_load_dword v9, v12, s[20:23], s40 offen sc1
L_SSK1_PW:
  s_add_u32 s60, s60, 1
  s_waitcnt vmcnt(0)
  v_cmp_eq_u32 vcc, -1, v9
  s_nop 1
  s_cmp_eq_u64 vcc, 0
  s_cbranch_scc1 L_SSK1_PO
  s_cmp_lt_u32 s60, 2000000
  s_cbranch_scc1 L_SSK1_P
L_SSK1_PO:
  s_mov_b64 exec, s[58:59]
  s_branch L_SRK1_LV
L_SRK1_EARLY:
  s_mov_b64 s[58:59], exec
  s_mov_b64 exec, 0x7
  buffer_load_dword v9, v12, s[20:23], s40 offen sc1
  s_mov_b64 exec, s[58:59]
  s_waitcnt lgkmcnt(0)
  v_mfma_f32_16x16x32_bf16 v[92:95], v[132:135], v[20:23], 0
  ds_read_b64_tr_b16 v[152:153], v10 offset:10368
  v_mfma_f32_16x16x32_bf16 v[112:115], v[132:135], v[56:59], 0
  ds_read_b64_tr_b16 v[154:155], v10 offset:10944
  v_mfma_f32_16x16x32_bf16 v[96:99], v[136:139], v[20:23], 0
  ds_read_b64_tr_b16 v[156:157], v10 offset:10400
  v_mfma_f32_16x16x32_bf16 v[116:119], v[136:139], v[56:59], 0
  ds_read_b64_tr_b16 v[158:159], v10 offset:10976
  v_mfma_f32_16x16x32_bf16 v[100:103], v[140:143], v[20:23], 0
  ds_read_b64_tr_b16 v[160:161], v10 offset:10432
  v_mfma_f32_16x16x32_bf16 v[120:123], v[140:143], v[56:59], 0
  ds_read_b64_tr_b16 v[162:163], v10 offset:11008
  v_mfma_f32_16x16x32_bf16 v[104:107], v[144:147], v[20:23], 0
  ds_read_b64_tr_b16 v[164:165], v10 offset:10464
  v_mfma_f32_16x16x32_bf16 v[124:127], v[144:147], v[56:59], 0
  ds_read_b64_tr_b16 v[166:167], v10 offset:11040
  v_mfma_f32_16x16x32_bf16 v[108:111], v[148:151], v[20:23], 0
  ds_read_b64_tr_b16 v[168:169], v10 offset:10496
  v_mfma_f32_16x16x32_bf16 v[128:131], v[148:151], v[56:59], 0
  ds_read_b64_tr_b16 v[170:171], v10 offset:11072
  s_waitcnt lgkmcnt(0)
  v_mfma_f32_16x16x32_bf16 v[92:95], v[152:155], v[24:27], v[92:95]
  ds_read_b64_tr_b16 v[132:133], v10 offset:20736
  v_mfma_f32_16x16x32_bf16 v[112:115], v[152:155], v[60:63], v[112:115]
  ds_read_b64_tr_b16 v[134:135], v10 offset:21312
  v_mfma_f32_16x16x32_bf16 v[96:99], v[156:159], v[24:27], v[96:99]
  ds_read_b64_tr_b16 v[136:137], v10 offset:20768
  v_mfma_f32_16x16x32_bf16 v[116:119], v[156:159], v[60:63], v[116:119]
  ds_read_b64_tr_b16 v[138:139], v10 offset:21344
  v_mfma_f32_16x16x32_bf16 v[100:103], v[160:163], v[24:27], v[100:103]
  ds_read_b64_tr_b16 v[140:141], v10 offset:20800
  v_mfma_f32_16x16x32_bf16 v[120:123], v[160:163], v[60:63], v[120:123]
  ds_read_b64_tr_b16 v[142:143], v10 offset:21376
  v_mfma_f32_16x16x32_bf16 v[104:107], v[164:167], v[24:27], v[104:107]
  ds_read_b64_tr_b16 v[144:145], v10 offset:20832
  v_mfma_f32_16x16x32_bf16 v[124:127], v[164:167], v[60:63], v[124:127]
  ds_read_b64_tr_b16 v[146:147], v10 offset:21408
  v_mfma_f32_16x16x32_bf16 v[108:111], v[168:171], v[24:27], v[108:111]
  ds_read_b64_tr_b16 v[148:149], v10 offset:20864
  v_mfma_f32_16x16x32_bf16 v[128:131], v[168:171], v[60:63], v[128:131]
  ds_read_b64_tr_b16 v[150:151], v10 offset:21440
  s_waitcnt lgkmcnt(0)
  v_mfma_f32_16x16x32_bf16 v[92:95], v[132:135], v[28:31], v[92:95]
  ds_read_b64_tr_b16 v[152:153], v10 offset:31104
  v_mfma_f32_16x16x32_bf16 v[112:115], v[132:135], v[64:67], v[112:115]
  ds_read_b64_tr_b16 v[154:155], v10 offset:31680
  v_mfma_f32_16x16x32_bf16 v[96:99], v[136:139], v[28:31], v[96:99]
  ds_read_b64_tr_b16 v[156:157], v10 offset:31136
  v_mfma_f32_16x16x32_bf16 v[116:119], v[136:139], v[64:67], v[116:119]
  ds_read_b64_tr_b16 v[158:159], v10 offset:31712
  v_mfma_f32_16x16x32_bf16 v[100:103], v[140:143], v[28:31], v[100:103]
  ds_read_b64_tr_b16 v[160:161], v10 offset:31168
  v_mfma_f32_16x16x32_bf16 v[120:123], v[140:143], v[64:67], v[120:123]
  ds_read_b64_tr_b16 v[162:163], v10 offset:31744
  v_mfma_f32_16x16x32_bf16 v[104:107], v[144:147], v[28:31], v[104:107]
  ds_read_b64_tr_b16 v[164:165], v10 offset:31200
  v_mfma_f32_16x16x32_bf16 v[124:127], v[144:147], v[64:67], v[124:127]
  ds_read_b64_tr_b16 v[166:167], v10 offset:31776
  v_mfma_f32_16x16x32_bf16 v[108:111], v[148:151], v[28:31], v[108:111]
  ds_read_b64_tr_b16 v[168:169], v10 offset:31232
  v_mfma_f32_16x16x32_bf16 v[128:131], v[148:151], v[64:67], v[128:131]
  ds_read_b64_tr_b16 v[170:171], v10 offset:31808
  s_waitcnt lgkmcnt(0)
  v_mfma_f32_16x16x32_bf16 v[92:95], v[152:155], v[32:35], v[92:95]
  ds_read_b64_tr_b16 v[132:133], v10 offset:5184
  v_mfma_f32_16x16x32_bf16 v[112:115], v[152:155], v[68:71], v[112:115]
  ds_read_b64_tr_b16 v[134:135], v10 offset:5760
  v_mfma_f32_16x16x32_bf16 v[96:99], v[156:159], v[32:35], v[96:99]
  ds_read_b64_tr_b16 v[136:137], v10 offset:5216
  v_mfma_f32_16x16x32_bf16 v[116:119], v[156:159], v[68:71], v[116:119]
  ds_read_b64_tr_b16 v[138:139], v10 offset:5792
  v_mfma_f32_16x16x32_bf16 v[100:103], v[160:163], v[32:35], v[100:103]
  ds_read_b64_tr_b16 v[140:141], v10 offset:5248
  v_mfma_f32_16x16x32_bf16 v[120:123], v[160:163], v[68:71], v[120:123]
  ds_read_b64_tr_b16 v[142:143], v10 offset:5824
  v_mfma_f32_16x16x32_bf16 v[104:107], v[164:167], v[32:35], v[104:107]
  ds_read_b64_tr_b16 v[144:145], v10 offset:5280
  v_mfma_f32_16x16x32_bf16 v[124:127], v[164:167], v[68:71], v[124:127]
  ds_read_b64_tr_b16 v[146:147], v10 offset:5856
  v_mfma_f32_16x16x32_bf16 v[108:111], v[168:171], v[32:35], v[108:111]
  ds_read_b64_tr_b16 v[148:149], v10 offset:5312
  v_mfma_f32_16x16x32_bf16 v[128:131], v[168:171], v[68:71], v[128:131]
  ds_read_b64_tr_b16 v[150:151], v10 offset:5888
  v_mov_b32 v2, 158748
  s_mov_b32 s60, 0
L_WOAK1:
  ds_read_b32 v3, v2
  s_add_u32 s60, s60, 1
  s_waitcnt lgkmcnt(0)
  v_readfirstlane_b32 s32, v3
  s_cmp_ge_u32 s32, 8
  s_cbranch_scc1 L_WOAK1_OK
  s_cmp_lt_u32 s60, 20000000
  s_cbranch_scc1 L_WOAK1
L_WOAK1_OK:
  s_mov_b64 s[58:59], exec
  s_mov_b64 exec, 0x7
  s_mov_b32 s60, 0
  s_branch L_SRK1_PW
L_SRK1_P:
  buffer_load_dword v9, v12, s[20:23], s40 offen sc1
L_SRK1_PW:
  s_add_u32 s60, s60, 1
  s_waitcnt vmcnt(0)
  v_cmp_eq_u32 vcc, -1, v9
  s_nop 1
  s_cmp_eq_u64 vcc, 0
  s_cbranch_scc1 L_SRK1_PO
  s_cmp_lt_u32 s60, 2000000
  s_cbranch_scc1 L_SRK1_P
L_SRK1_PO:
  s_mov_b64 exec, s[58:59]
L_SRK1_LV:
  s_mov_b32 s50, 0
L_SRVK1_L:
  s_add_u32 s32, s40, 10240
  s_add_u32 s33, s40, 26624
  buffer_load_dwordx4 v[36:39], v14, s[20:23], s32 offen sc1
  buffer_load_dwordx4 v[72:75], v14, s[20:23], s33 offen sc1
  s_add_u32 s32, s40, 12288
  s_add_u32 s33, s40, 28672
  buffer_load_dwordx4 v[40:43], v14, s[20:23], s32 offen sc1
  buffer_load_dwordx4 v[76:79], v14, s[20:23], s33 offen sc1
  s_add_u32 s32, s40, 14336
  s_add_u32 s33, s40, 30720
  buffer_load_dwordx4 v[44:47], v14, s[20:23], s32 offen sc1
  buffer_load_dwordx4 v[80:83], v14, s[20:23], s33 offen sc1
  s_add_u32 s32, s68, 0
  buffer_load_dword v48, v16, s[20:23], s32 offen offset:0 sc1
  buffer_load_dword v49, v16, s[20:23], s32 offen offset:1024 sc1
  buffer_load_dword v50, v16, s[20:23], s32 offen offset:2048 sc1
  buffer_load_dword v51, v16, s[20:23], s32 offen offset:3072 sc1
  buffer_load_dword v84, v17, s[20:23], s32 offen offset:0 sc1
  buffer_load_dword v85, v17, s[20:23], s32 offen offset:1024 sc1
  buffer_load_dword v86, v17, s[20:23], s32 offen offset:2048 sc1
  buffer_load_dword v87, v17, s[20:23], s32 offen offset:3072 sc1
  s_add_u32 s32, s68, 16384
  buffer_load_dword v52, v16, s[20:23], s32 offen offset:0 sc1
  buffer_load_dword v53, v16, s[20:23], s32 offen offset:1024 sc1
  buffer_load_dword v54, v16, s[20:23], s32 offen offset:2048 sc1
  buffer_load_dword v55, v16, s[20:23], s32 offen offset:3072 sc1
  buffer_load_dword v88, v17, s[20:23], s32 offen offset:0 sc1
  buffer_load_dword v89, v17, s[20:23], s32 offen offset:1024 sc1
  buffer_load_dword v90, v17, s[20:23], s32 offen offset:2048 sc1
  buffer_load_dword v91, v17, s[20:23], s32 offen offset:3072 sc1
  s_waitcnt vmcnt(20)
  v_max3_u32 v5, v36, v37, v38
  v_max_u32 v5, v5, v39
  v_max3_u32 v5, v5, v72, v73
  v_max3_u32 v5, v5, v74, v75
  s_waitcnt vmcnt(18)
  v_max3_u32 v5, v5, v40, v41
  v_max3_u32 v5, v5, v42, v43
  v_max3_u32 v5, v5, v76, v77
  v_max3_u32 v5, v5, v78, v79
  s_waitcnt vmcnt(16)
  v_max3_u32 v5, v5, v44, v45
  v_max3_u32 v5, v5, v46, v47
  v_max3_u32 v5, v5, v80, v81
  v_max3_u32 v5, v5, v82, v83
  s_waitcnt vmcnt(8)
  v_max3_u32 v5, v5, v48, v49
  v_max3_u32 v5, v5, v50, v51
  v_max3_u32 v5, v5, v84, v85
  v_max3_u32 v5, v5, v86, v87
  s_waitcnt vmcnt(0)
  v_max3_u32 v5, v5, v52, v53
  v_max3_u32 v5, v5, v54, v55
  v_max3_u32 v5, v5, v88, v89
  v_max3_u32 v5, v5, v90, v91
  v_cmp_eq_u32 vcc, -1, v5
  s_nop 1
  s_cmp_eq_u64 vcc, 0
  s_cbranch_scc1 L_SRVK1_OK
  s_add_u32 s50, s50, 1
  s_cmp_lt_u32 s50, 100000
  s_cbranch_scc1 L_SRVK1_L
L_SRVK1_OK:
  s_waitcnt lgkmcnt(0)
  v_mfma_f32_16x16x32_bf16 v[92:95], v[132:135], v[36:39], v[92:95]
  ds_read_b64_tr_b16 v[152:153], v10 offset:15552
  v_mfma_f32_16x16x32_bf16 v[112:115], v[132:135], v[72:75], v[112:115]
  ds_read_b64_tr_b16 v[154:155], v10 offset:16128
  v_mfma_f32_16x16x32_bf16 v[96:99], v[136:139], v[36:39], v[96:99]
  ds_read_b64_tr_b16 v[156:157], v10 offset:15584
  v_mfma_f32_16x16x32_bf16 v[116:119], v[136:139], v[72:75], v[116:119]
  ds_read_b64_tr_b16 v[158:159], v10 offset:16160
  v_mfma_f32_16x16x32_bf16 v[100:103], v[140:143], v[36:39], v[100:103]
  ds_read_b64_tr_b16 v[160:161], v10 offset:15616
  v_mfma_f32_16x16x32_bf16 v[120:123], v[140:143], v[72:75], v[120:123]
  ds_read_b64_tr_b16 v[162:163], v10 offset:16192
  v_mfma_f32_16x16x32_bf16 v[104:107], v[144:147], v[36:39], v[104:107]
  ds_read_b64_tr_b16 v[164:165], v10 offset:15648
  v_mfma_f32_16x16x32_bf16 v[124:127], v[144:147], v[72:75], v[124:127]
  ds_read_b64_tr_b16 v[166:167], v10 offset:16224
  v_mfma_f32_16x16x32_bf16 v[108:111], v[148:151], v[36:39], v[108:111]
  ds_read_b64_tr_b16 v[168:169], v10 offset:15680
  v_mfma_f32_16x16x32_bf16 v[128:131], v[148:151], v[72:75], v[128:131]
  ds_read_b64_tr_b16 v[170:171], v10 offset:16256
  s_waitcnt lgkmcnt(0)
  v_mfma_f32_16x16x32_bf16 v[92:95], v[152:155], v[40:43], v[92:95]
  ds_read_b64_tr_b16 v[132:133], v10 offset:25920
  v_mfma_f32_16x16x32_bf16 v[112:115], v[152:155], v[76:79], v[112:115]
  ds_read_b64_tr_b16 v[134:135], v10 offset:26496
  v_mfma_f32_16x16x32_bf16 v[96:99], v[156:159], v[40:43], v[96:99]
  ds_read_b64_tr_b16 v[136:137], v10 offset:25952
  v_mfma_f32_16x16x32_bf16 v[116:119], v[156:159], v[76:79], v[116:119]
  ds_read_b64_tr_b16 v[138:139], v10 offset:26528
  v_mfma_f32_16x16x32_bf16 v[100:103], v[160:163], v[40:43], v[100:103]
  ds_read_b64_tr_b16 v[140:141], v10 offset:25984
  v_mfma_f32_16x16x32_bf16 v[120:123], v[160:163], v[76:79], v[120:123]
  ds_read_b64_tr_b16 v[142:143], v10 offset:26560
  v_mfma_f32_16x16x32_bf16 v[104:107], v[164:167], v[40:43], v[104:107]
  ds_read_b64_tr_b16 v[144:145], v10 offset:26016
  v_mfma_f32_16x16x32_bf16 v[124:127], v[164:167], v[76:79], v[124:127]
  ds_read_b64_tr_b16 v[146:147], v10 offset:26592
  v_mfma_f32_16x16x32_bf16 v[108:111], v[168:171], v[40:43], v[108:111]
  ds_read_b64_tr_b16 v[148:149], v10 offset:26048
  v_mfma_f32_16x16x32_bf16 v[128:131], v[168:171], v[76:79], v[128:131]
  ds_read_b64_tr_b16 v[150:151], v10 offset:26624
  s_waitcnt lgkmcnt(0)
  v_mfma_f32_16x16x32_bf16 v[92:95], v[132:135], v[44:47], v[92:95]
  ds_read_b64_tr_b16 v[152:153], v11 offset:0
  v_mfma_f32_16x16x32_bf16 v[112:115], v[132:135], v[80:83], v[112:115]
  ds_read_b64_tr_b16 v[154:155], v11 offset:5184
  v_mfma_f32_16x16x32_bf16 v[96:99], v[136:139], v[44:47], v[96:99]
  ds_read_b64_tr_b16 v[156:157], v11 offset:32
  v_mfma_f32_16x16x32_bf16 v[116:119], v[136:139], v[80:83], v[116:119]
  ds_read_b64_tr_b16 v[158:159], v11 offset:5216
  v_mfma_f32_16x16x32_bf16 v[100:103], v[140:143], v[44:47], v[100:103]
  ds_read_b64_tr_b16 v[160:161], v11 offset:64
  v_mfma_f32_16x16x32_bf16 v[120:123], v[140:143], v[80:83], v[120:123]
  ds_read_b64_tr_b16 v[162:163], v11 offset:5248
  v_mfma_f32_16x16x32_bf16 v[104:107], v[144:147], v[44:47], v[104:107]
  ds_read_b64_tr_b16 v[164:165], v11 offset:96
  v_mfma_f32_16x16x32_bf16 v[124:127], v[144:147], v[80:83], v[124:127]
  ds_read_b64_tr_b16 v[166:167], v11 offset:5280
  v_mfma_f32_16x16x32_bf16 v[108:111], v[148:151], v[44:47], v[108:111]
  ds_read_b64_tr_b16 v[168:169], v11 offset:128
  v_mfma_f32_16x16x32_bf16 v[128:131], v[148:151], v[80:83], v[128:131]
  ds_read_b64_tr_b16 v[170:171], v11 offset:5312
  s_waitcnt lgkmcnt(0)
  v_mfma_f32_16x16x32_bf16 v[92:95], v[152:155], v[48:51], v[92:95]
  ds_read_b64_tr_b16 v[132:133], v11 offset:41472
  v_mfma_f32_16x16x32_bf16 v[112:115], v[152:155], v[84:87], v[112:115]
  ds_read_b64_tr_b16 v[134:135], v11 offset:46656
  v_mfma_f32_16x16x32_bf16 v[96:99], v[156:159], v[48:51], v[96:99]
  ds_read_b64_tr_b16 v[136:137], v11 offset:41504
  v_mfma_f32_16x16x32_bf16 v[116:119], v[156:159], v[84:87], v[116:119]
  ds_read_b64_tr_b16 v[138:139], v11 offset:46688
  v_mfma_f32_16x16x32_bf16 v[100:103], v[160:163], v[48:51], v[100:103]
  ds_read_b64_tr_b16 v[140:141], v11 offset:41536
  v_mfma_f32_16x16x32_bf16 v[120:123], v[160:163], v[84:87], v[120:123]
  ds_read_b64_tr_b16 v[142:143], v11 offset:46720
  v_mfma_f32_16x16x32_bf16 v[104:107], v[164:167], v[48:51], v[104:107]
  ds_read_b64_tr_b16 v[144:145], v11 offset:41568
  v_mfma_f32_16x16x32_bf16 v[124:127], v[164:167], v[84:87], v[124:127]
  ds_read_b64_tr_b16 v[146:147], v11 offset:46752
  v_mfma_f32_16x16x32_bf16 v[108:111], v[168:171], v[48:51], v[108:111]
  ds_read_b64_tr_b16 v[148:149], v11 offset:41600
  v_mfma_f32_16x16x32_bf16 v[128:131], v[168:171], v[84:87], v[128:131]
  ds_read_b64_tr_b16 v[150:151], v11 offset:46784
  s_waitcnt lgkmcnt(0)
  v_mfma_f32_16x16x32_bf16 v[92:95], v[132:135], v[52:55], v[92:95]
  v_mfma_f32_16x16x32_bf16 v[112:115], v[132:135], v[88:91], v[112:115]
  v_mfma_f32_16x16x32_bf16 v[96:99], v[136:139], v[52:55], v[96:99]
  v_mfma_f32_16x16x32_bf16 v[116:119], v[136:139], v[88:91], v[116:119]
  v_mfma_f32_16x16x32_bf16 v[100:103], v[140:143], v[52:55], v[100:103]
  v_mfma_f32_16x16x32_bf16 v[120:123], v[140:143], v[88:91], v[120:123]
  v_mfma_f32_16x16x32_bf16 v[104:107], v[144:147], v[52:55], v[104:107]
  v_mfma_f32_16x16x32_bf16 v[124:127], v[144:147], v[88:91], v[124:127]
  v_mfma_f32_16x16x32_bf16 v[108:111], v[148:151], v[52:55], v[108:111]
  v_mfma_f32_16x16x32_bf16 v[128:131], v[148:151], v[88:91], v[128:131]
  s_nop 7
  ds_write_b128 v18, v[92:95] offset:0
  ds_write_b128 v18, v[96:99] offset:1024
  ds_write_b128 v18, v[100:103] offset:2048
  ds_write_b128 v18, v[104:107] offset:3072
  ds_write_b128 v18, v[108:111] offset:4096
  s_waitcnt lgkmcnt(0)
  s_barrier
  ds_read_b128 v[20:23], v19 offset:0
  ds_read_b128 v[24:27], v19 offset:1024
  ds_read_b128 v[28:31], v19 offset:2048
  ds_read_b128 v[32:35], v19 offset:3072
  ds_read_b128 v[36:39], v19 offset:4096
  s_waitcnt lgkmcnt(4)
  v_add_f32 v20, v20, v112
  v_add_f32 v21, v21, v113
  v_add_f32 v22, v22, v114
  v_add_f32 v23, v23, v115
  v_cvt_pk_bf16_f32 v40, v20, v21
  v_cvt_pk_bf16_f32 v41, v22, v23
  buffer_store_dwordx2 v[40:41], v15, s[24:27], s37 offen offset:0
  s_waitcnt lgkmcnt(3)
  v_add_f32 v24, v24, v116
  v_add_f32 v25, v25, v117
  v_add_f32 v26, v26, v118
  v_add_f32 v27, v27, v119
  v_cvt_pk_bf16_f32 v42, v24, v25
  v_cvt_pk_bf16_f32 v43, v26, v27
  buffer_store_dwordx2 v[42:43], v15, s[24:27], s37 offen offset:32
  s_waitcnt lgkmcnt(2)
  v_add_f32 v28, v28, v120
  v_add_f32 v29, v29, v121
  v_add_f32 v30, v30, v122
  v_add_f32 v31, v31, v123
  v_cvt_pk_bf16_f32 v44, v28, v29
  v_cvt_pk_bf16_f32 v45, v30, v31
  buffer_store_dwordx2 v[44:45], v15, s[24:27], s37 offen offset:64
  s_waitcnt lgkmcnt(1)
  v_add_f32 v32, v32, v124
  v_add_f32 v33, v33, v125
  v_add_f32 v34, v34, v126
  v_add_f32 v35, v35, v127
  v_cvt_pk_bf16_f32 v46, v32, v33
  v_cvt_pk_bf16_f32 v47, v34, v35
  buffer_store_dwordx2 v[46:47], v15, s[24:27], s37 offen offset:96
  s_waitcnt lgkmcnt(0)
  v_add_f32 v36, v36, v128
  v_add_f32 v37, v37, v129
  v_add_f32 v38, v38, v130
  v_add_f32 v39, v39, v131
  v_cvt_pk_bf16_f32 v48, v36, v37
  v_cvt_pk_bf16_f32 v49, v38, v39
  s_mov_b64 s[58:59], exec
  s_mov_b32 exec_hi, 0
  buffer_store_dwordx2 v[48:49], v15, s[24:27], s37 offen offset:128
  s_mov_b64 exec, s[58:59]
  s_cmp_lg_u32 s30, 0
  s_cbranch_scc1 L_FIN
  s_cmp_lg_u32 s31, 4
  s_cbranch_scc1 L_FIN
  v_mov_b32 v2, 0
  v_mov_b32 v3, s42
  s_mov_b64 exec, 1
  buffer_store_dword v3, v2, s[20:23], s5 offen sc1
L_FIN:
L_END:
  s_endpgm
  .section .rodata,"a"
  .p2align 6
  .amdhsa_kernel concat_heads__sliding_block__sliding_block__prompt_kernel
  .amdhsa_next_free_vgpr 256
  .amdhsa_next_free_sgpr 102
  .amdhsa_accum_offset 256
  .amdhsa_group_segment_fixed_size 0
  .amdhsa_kernarg_size 72
  .amdhsa_user_sgpr_count 2
  .amdhsa_user_sgpr_kernarg_segment_ptr 1
  .amdhsa_system_sgpr_workgroup_id_x 1
  .end_amdhsa_kernel
```
